```python
import torch

def _softmax(x, axis=-1):
    return torch.softmax(x, dim=axis)
def _gelu(x):
    return torch.nn.functional.gelu(x, approximate="tanh")
def _silu(x):
    return torch.nn.functional.silu(x)
def _sigmoid(x):
    return torch.sigmoid(x)
def _layernorm(x, axis=-1, eps=1e-5):
    m = x.mean(dim=axis, keepdim=True)
    v = x.var(dim=axis, keepdim=True, unbiased=False)
    return (x - m) / torch.sqrt(v + eps)
def _scatter_add(tgt, idx, src, axis=0):
    return tgt.clone().index_add_(axis, idx, src)
def _segment_sum(src, seg, n):
    out = torch.zeros((n,) + src.shape[1:], dtype=src.dtype)
    return out.index_add_(0, seg, src)
def _pad(x, pw):
    flat = tuple(v for pair in reversed(pw) for v in pair)
    return torch.nn.functional.pad(x, flat)

kernel_name = 'sequential_preLN__grouped_kv_mqa__dense_activation_mish__prompt'

def setup_inputs():

    _w = (lambda a: (lambda t: t.to(torch.bfloat16) if t.is_floating_point() else t)(torch.as_tensor(a)))
    def _A_setup():
        B, S, D, H = 1, 2048, 448, 16
        Dh = D // H
        return {
            "x": _w((lambda *s: torch.randn(*s, dtype=torch.bfloat16) * 0.05)(B, S, D)),
            "wq": _w((lambda *s: torch.randn(*s, dtype=torch.bfloat16) * 0.05)(D, H * Dh)),
            "wk": _w((lambda *s: torch.randn(*s, dtype=torch.bfloat16) * 0.05)(D, Dh)),
            "wv": _w((lambda *s: torch.randn(*s, dtype=torch.bfloat16) * 0.05)(D, Dh)),
            "wo": _w((lambda *s: torch.randn(*s, dtype=torch.bfloat16) * 0.05)(H * Dh, D)),
        }
    _A_in = _A_setup()

    def _B_setup():
        B, S, D, F = 1, 2048, 448, 1792
        return {
            "x": _w((lambda *s: torch.randn(*s, dtype=torch.bfloat16) * 0.05)(B, S, D)),
            "w1": _w((lambda *s: torch.randn(*s, dtype=torch.bfloat16) * 0.8)(D, F) * (D ** -0.5)),
            "b1": _w((lambda *s: torch.randn(*s, dtype=torch.bfloat16) * 0.8)(F)),
            "w2": _w((lambda *s: torch.randn(*s, dtype=torch.bfloat16) * 0.2)(F, D) * (F ** -0.5)),
        }
    _B_in = _B_setup()

    return {
        "A_x": _A_in["x"],
        "A_wq": _A_in["wq"],
        "A_wk": _A_in["wk"],
        "A_wv": _A_in["wv"],
        "A_wo": _A_in["wo"],
        "B_x": _B_in["x"],
        "B_w1": _B_in["w1"],
        "B_b1": _B_in["b1"],
        "B_w2": _B_in["w2"],
    }

def reference(A_x, A_wq, A_wk, A_wv, A_wo, B_x, B_w1, B_b1, B_w2):
    def _A_ref(x, wq, wk, wv, wo):
        B, S, D = x.shape
        H = 16
        Dh = D // H
        q = (lambda x, *d: x.permute(*d))((x @ wq).reshape(B, S, H, Dh), 0, 2, 1, 3)
        k = x @ wk
        v = x @ wv
        scores = torch.einsum("bhqd,bkd->bhqk", q, k) * (Dh ** -0.5)
        p = _softmax(scores, axis=-1)
        o = torch.einsum("bhqk,bkd->bhqd", p, v)
        return (lambda x, *d: x.permute(*d))(o, 0, 2, 1, 3).reshape(B, S, H * Dh) @ wo

    def _B_ref(x, w1, b1, w2):
        h = torch.einsum("bsd,df->bsf", x, w1) + b1
        sp = torch.log1p(torch.exp(-torch.abs(h))) + torch.where(h > 0, h, torch.zeros_like(h))
        act = h * torch.tanh(sp)
        return torch.einsum("bsf,fd->bsd", act, w2)

    x = A_x
    h = x + _A_ref(_layernorm(x, axis=-1), A_wq, A_wk, A_wv, A_wo)
    h2 = h + _B_ref(_layernorm(h, axis=-1), B_w1, B_b1, B_w2)
    return h2
```

```asm
; @launch grid=(256,1,1) block=(256,1,1) lds=163840
.amdgcn_target "amdgcn-amd-amdhsa--gfx950"
.text
.globl sequential_preLN__grouped_kv_mqa__dense_activation_mish__prompt_kernel
.p2align 12
.fill 832, 4, 0xbf800000
.p2align 8
.type sequential_preLN__grouped_kv_mqa__dense_activation_mish__prompt_kernel,@function
sequential_preLN__grouped_kv_mqa__dense_activation_mish__prompt_kernel:
    s_cmp_ge_u32 s2, 256
    s_cbranch_scc1 KB_end
    s_load_dwordx4 s[24:27], s[0:1], 0
    s_load_dwordx4 s[28:31], s[0:1], 16
    s_load_dwordx4 s[92:95], s[0:1], 80
    s_load_dwordx2 s[32:33], s[0:1], 32
    s_load_dwordx4 s[36:39], s[0:1], 48
    s_load_dwordx4 s[40:43], s[0:1], 64
    s_getpc_b64 s[0:1]
KB_pc:
    s_lshr_b32 s52, s2, 3
    s_lshl_b32 s52, s52, 15
    v_lshl_add_u32 v183, v0, 7, s52
    v_lshrrev_b32 v4, 6, v0
    v_min_u32 v183, KB_code_end-KB_pc-4, v183
    v_and_b32 v0, 63, v0
    global_load_dword v165, v183, s[0:1]
    v_readfirstlane_b32 s3, v4
    s_and_b32 s4, s2, 7
    s_lshl_b32 s4, s4, 2
    s_bfe_u32 s5, s2, 0x20003
    s_add_u32 s4, s4, s5
    s_lshr_b32 s5, s2, 5
    v_lshrrev_b32 v178, 3, v0
    v_and_b32 v179, 7, v0
    s_and_b32 s6, s3, 1
    s_lshr_b32 s7, s3, 1
    v_lshrrev_b32 v184, 1, v178
    v_xor_b32 v181, v179, v184
    s_lshl_b32 s44, s6, 2
    v_xor_b32 v181, s44, v181
    v_mul_u32_u24 v180, 896, v178
    v_lshl_add_u32 v181, v181, 4, v180
    s_lshl_b32 s44, s4, 6
    s_lshl_b32 s45, s3, 4
    s_add_u32 s44, s44, s45
    s_mul_i32 s44, s44, 896
    s_mul_i32 s45, s3, 14336
    s_mov_b32 s10, 1835008
    s_mov_b32 s11, 0x20000
    s_mov_b32 s15, 0x20000
    v_lshlrev_b32 v1, 4, v0
    s_cmp_eq_u32 s5, 0
    s_cbranch_scc1 P1_kv
    s_sub_u32 s68, s5, 1
    v_and_b32 v186, 1, v184
    v_lshlrev_b32 v186, 2, v186
    v_xor_b32 v186, v179, v186
    v_lshlrev_b32 v186, 4, v186
    v_add_u32 v180, v180, v186
    s_mul_i32 s46, s3, 16*896
    s_lshl_b32 s47, s68, 7
    s_add_u32 s46, s46, s47
    s_lshl_b32 s47, s3, 11
    s_add_u32 s47, s47, 57344
    s_and_b32 s48, s4, 3
    s_mul_i32 s48, s48, 2
    s_add_u32 s48, s48, s68
    s_cmp_ge_u32 s48, 7
    s_cselect_b32 s49, 7, 0
    s_sub_u32 s48, s48, s49
    s_mov_b32 s14, 401408
    s_mov_b64 s[54:55], 0
    v_mov_b32 v166, 0
    s_lshl_b32 s52, s68, 1
    s_add_u32 s52, s52, s6
    s_lshl_b32 s52, s52, 5
    s_add_u32 s52, s52, KB_qtab-KB_pc
    s_sub_u32 s50, s2, 224
    s_cmp_lt_u32 s50, 8
    s_waitcnt lgkmcnt(0)
    s_mov_b32 s8, s24
    s_mov_b32 s9, s25
    s_mov_b32 s12, s26
    s_mov_b32 s13, s27
    s_cbranch_scc1 P1_clr
P1_clr_done:
    s_lshl_b32 s49, s48, 7
    s_add_u32 s49, s49, s44
    s_add_u32 m0, s45, 0
    s_mul_i32 s50, s48, 64*896
    buffer_load_dwordx4 v181, s[8:11], s49 offen lds
    s_add_u32 s49, s49, 8*896
    s_add_u32 m0, s45, 7168
    s_add_u32 s50, s50, s46
    buffer_load_dwordx4 v181, s[8:11], s49 offen lds
    s_add_u32 m0, s47, 0
    s_add_u32 s48, s48, 1
    buffer_load_dwordx4 v180, s[12:15], s50 offen lds
    s_add_u32 s50, s50, 8*896
    s_add_u32 m0, s47, 1024
    s_cmp_eq_u32 s48, 7
    s_cselect_b32 s48, 0, s48
    buffer_load_dwordx4 v180, s[12:15], s50 offen lds
    s_load_dwordx8 s[24:31], s[0:1], s52
    v_lshrrev_b32 v2, 5, v0
    v_bfe_u32 v177, v0, 2, 2
    v_bfe_u32 v176, v0, 4, 1
    v_and_b32 v6, 3, v0
    s_lshl_b32 s49, s48, 7
    s_add_u32 s49, s49, s44
    s_add_u32 m0, s45, 1024
    s_mul_i32 s50, s48, 64*896
    buffer_load_dwordx4 v181, s[8:11], s49 offen lds
    v_and_b32 v5, 31, v0
    v_lshl_add_u32 v182, v2, 3, v177
    v_lshrrev_b32 v183, 1, v177
    v_xor_b32 v183, s6, v183
    s_add_u32 s49, s49, 8*896
    s_add_u32 m0, s45, 8192
    s_add_u32 s50, s50, s46
    buffer_load_dwordx4 v181, s[8:11], s49 offen lds
    v_lshlrev_b32 v182, 7, v182
    v_lshl_add_u32 v182, v183, 6, v182
    v_add_u32 v182, 57344, v182
    v_lshl_add_u32 v182, v176, 5, v182
    s_add_u32 m0, s47, 8192
    s_add_u32 s48, s48, 1
    buffer_load_dwordx4 v180, s[12:15], s50 offen lds
    v_lshl_add_u32 v182, v6, 3, v182
    v_bfe_u32 v184, v5, 1, 2
    v_lshrrev_b32 v185, 2, v5
    v_and_b32 v185, 4, v185
    s_add_u32 s50, s50, 8*896
    s_add_u32 m0, s47, 9216
    s_cmp_eq_u32 s48, 7
    s_cselect_b32 s48, 0, s48
    buffer_load_dwordx4 v180, s[12:15], s50 offen lds
    v_or_b32 v184, v184, v185
    v_xor_b32 v184, v184, v2
    v_lshrrev_b32 v185, 3, v5
    v_mul_u32_u24 v185, 7168, v185
    s_lshl_b32 s49, s48, 7
    s_add_u32 s49, s49, s44
    s_add_u32 m0, s45, 2048
    s_mul_i32 s50, s48, 64*896
    buffer_load_dwordx4 v181, s[8:11], s49 offen lds
    v_lshl_add_u32 v185, v179, 7, v185
    s_mul_i32 s51, s7, 28672
    v_add_u32 v185, s51, v185
    v_lshl_add_u32 v196, v184, 4, v185
    s_add_u32 s49, s49, 8*896
    s_add_u32 m0, s45, 9216
    s_add_u32 s50, s50, s46
    buffer_load_dwordx4 v181, s[8:11], s49 offen lds
    v_xor_b32 v197, 32, v196
    v_xor_b32 v198, 64, v196
    v_xor_b32 v199, 96, v196
    v_bfe_u32 v184, v0, 3, 1
    s_add_u32 m0, s47, 16384
    s_add_u32 s48, s48, 1
    buffer_load_dwordx4 v180, s[12:15], s50 offen lds
    v_mul_u32_u24 v184, 7168, v184
    v_lshl_add_u32 v184, v179, 7, v184
    v_lshrrev_b32 v183, 4, v0
    v_lshrrev_b32 v200, 1, v179
    s_add_u32 s50, s50, 8*896
    s_add_u32 m0, s47, 17408
    s_cmp_eq_u32 s48, 7
    s_cselect_b32 s48, 0, s48
    buffer_load_dwordx4 v180, s[12:15], s50 offen lds
    v_xor_b32 v183, v183, v200
    v_lshl_add_u32 v184, v183, 4, v184
    v_add_u32 v200, s45, v184
    v_xor_b32 v201, 64, v200
    s_branch P1_q
P1_clr:
    v_mov_b32 v208, 0
    v_mov_b32 v209, 0
    v_mov_b32 v210, 0
    v_mov_b32 v211, 0
    s_lshl_b32 s51, s50, 2
    s_add_u32 s51, s51, s3
    s_lshl_b32 s51, s51, 12
    s_add_u32 s51, s51, 2359296
    s_add_u32 s66, s94, s51
    s_addc_u32 s67, s95, 0
    global_store_dwordx4 v1, v[208:211], s[66:67] sc0 sc1
    global_store_dwordx4 v1, v[208:211], s[66:67] offset:1024 sc0 sc1
    s_and_b32 s51, s50, 1
    s_lshl_b32 s51, s51, 7
    s_lshr_b32 s50, s50, 1
    s_add_u32 s51, s51, s50
    v_mov_b32 v166, s51
    v_mov_b32 v167, 1
    s_cmp_eq_u32 s3, 0
    s_cselect_b32 s54, 1, 0
    s_branch P1_clr_done
P1_kv:
    s_lshl_b32 s46, s7, 10
    s_mul_i32 s47, s6, 28672
    s_add_u32 s47, s47, s46
    s_add_u32 s47, s47, 57344
    s_mov_b32 s14, 25088
    s_cmp_eq_u32 s6, 0
    s_waitcnt lgkmcnt(0)
    s_cselect_b32 s12, s28, s30
    s_cselect_b32 s13, s29, s31
    s_mov_b32 s8, s24
    s_mov_b32 s9, s25
    s_add_u32 m0, s45, 0
    s_add_u32 s49, s44, 0
    buffer_load_dwordx4 v181, s[8:11], s49 offen lds
    s_add_u32 m0, s45, 7168
    s_add_u32 s49, s44, 7168
    buffer_load_dwordx4 v181, s[8:11], s49 offen lds
    s_add_u32 m0, s47, 0
    s_add_u32 s50, s46, 0
    buffer_load_dwordx4 v1, s[12:15], s50 offen lds
    s_add_u32 m0, s47, 2048
    s_add_u32 s50, s46, 2048
    buffer_load_dwordx4 v1, s[12:15], s50 offen lds
    v_lshrrev_b32 v2, 5, v0
    v_bfe_u32 v177, v0, 2, 2
    v_bfe_u32 v176, v0, 4, 1
    v_and_b32 v6, 3, v0
    s_add_u32 m0, s45, 1024
    s_add_u32 s49, s44, 128
    buffer_load_dwordx4 v181, s[8:11], s49 offen lds
    v_and_b32 v5, 31, v0
    v_lshl_add_u32 v182, v2, 3, v177
    s_sub_u32 s51, s47, s46
    v_mul_u32_u24 v182, 56, v182
    s_add_u32 m0, s45, 8192
    s_add_u32 s49, s44, 7296
    buffer_load_dwordx4 v181, s[8:11], s49 offen lds
    v_add_u32 v182, s51, v182
    v_lshl_add_u32 v182, v176, 5, v182
    v_lshl_add_u32 v182, v6, 3, v182
    v_bfe_u32 v184, v5, 1, 2
    s_add_u32 m0, s47, 4096
    s_add_u32 s50, s46, 4096
    buffer_load_dwordx4 v1, s[12:15], s50 offen lds
    v_lshrrev_b32 v185, 2, v5
    v_and_b32 v185, 4, v185
    v_or_b32 v184, v184, v185
    v_xor_b32 v184, v184, v2
    s_add_u32 m0, s47, 6144
    s_add_u32 s50, s46, 6144
    buffer_load_dwordx4 v1, s[12:15], s50 offen lds
    v_lshrrev_b32 v185, 3, v5
    v_mul_u32_u24 v185, 7168, v185
    v_lshl_add_u32 v185, v179, 7, v185
    s_add_u32 m0, s45, 2048
    s_add_u32 s49, s44, 256
    buffer_load_dwordx4 v181, s[8:11], s49 offen lds
    s_mul_i32 s51, s7, 28672
    v_add_u32 v185, s51, v185
    v_lshl_add_u32 v196, v184, 4, v185
    v_xor_b32 v197, 32, v196
    s_add_u32 m0, s45, 9216
    s_add_u32 s49, s44, 7424
    buffer_load_dwordx4 v181, s[8:11], s49 offen lds
    v_xor_b32 v198, 64, v196
    v_xor_b32 v199, 96, v196
    v_bfe_u32 v184, v0, 3, 1
    v_mul_u32_u24 v184, 7168, v184
    s_add_u32 m0, s47, 8192
    s_add_u32 s50, s46, 8192
    buffer_load_dwordx4 v1, s[12:15], s50 offen lds
    v_lshl_add_u32 v184, v179, 7, v184
    v_lshrrev_b32 v183, 4, v0
    v_lshrrev_b32 v200, 1, v179
    v_xor_b32 v183, v183, v200
    s_add_u32 m0, s47, 10240
    s_add_u32 s50, s46, 10240
    buffer_load_dwordx4 v1, s[12:15], s50 offen lds
    v_lshl_add_u32 v184, v183, 4, v184
    v_add_u32 v200, s45, v184
    v_xor_b32 v201, 64, v200
    s_mov_b32 s16, s94
    s_mov_b32 s17, s95
    s_mov_b32 s18, 0x1d00000
    s_mov_b32 s19, 0x20000
    s_lshl_b32 s52, s4, 1
    s_add_u32 s52, s52, s7
    s_lshl_b32 s52, s52, 1
    s_add_u32 s52, s52, s6
    s_lshl_b32 s52, s52, 11
    s_add_u32 s68, s52, 2097152
    s_add_u32 s88, s52, 4849664
    v_mov_b32 v212, -1
    v_mov_b32 v213, -1
    v_mov_b32 v214, -1
    v_mov_b32 v215, -1
    buffer_store_dwordx4 v[212:215], v1, s[16:19], s88 offen offset:0
    buffer_store_dwordx4 v[212:215], v1, s[16:19], s88 offen offset:1024
    buffer_store_dwordx4 v[212:215], v1, s[16:19], s68 offen offset:0 sc1
    buffer_store_dwordx4 v[212:215], v1, s[16:19], s68 offen offset:1024 sc1
    s_cmp_eq_u32 s6, 0
    s_cbranch_scc1 P1_k
    s_branch P1_v
.p2align 5
KB_qtab:
.long 0x0, 0x200, 0x8, 0x200, 0x400, 0x200, 0x408, 0xfffffc78
.long 0x280, 0xfffffe08, 0x288, 0x1f8, 0x680, 0xfffffe08, 0x100, 0x200
.long 0x108, 0x200, 0x500, 0x200, 0x508, 0xfffffc78, 0x380, 0xfffffe08
.long 0x388, 0x1f8, 0x780, 0xfffffe08, 0x800, 0x200, 0x808, 0x200
.long 0xc00, 0x200, 0xc08, 0xfffffc78, 0xa80, 0xfffffe08, 0xa88, 0x1f8
.long 0xe80, 0xfffffe08, 0x900, 0x200, 0x908, 0x200, 0xd00, 0x200
.long 0xd08, 0xfffffc78, 0xb80, 0xfffffe08, 0xb88, 0x1f8, 0xf80, 0xfffffe08
.long 0x1000, 0x200, 0x1008, 0x200, 0x1400, 0x200, 0x1408, 0xfffffc78
.long 0x1280, 0xfffffe08, 0x1288, 0x1f8, 0x1680, 0xfffffe08, 0x1100, 0x200
.long 0x1108, 0x200, 0x1500, 0x200, 0x1508, 0xfffffc78, 0x1380, 0xfffffe08
.long 0x1388, 0x1f8, 0x1780, 0xfffffe08, 0x1800, 0x200, 0x1808, 0x200
.long 0x1c00, 0x200, 0x1c08, 0xfffffc78, 0x1a80, 0xfffffe08, 0x1a88, 0x1f8
.long 0x1e80, 0xfffffe08, 0x1900, 0x200, 0x1908, 0x200, 0x1d00, 0x200
.long 0x1d08, 0xfffffc78, 0x1b80, 0xfffffe08, 0x1b88, 0x1f8, 0x1f80, 0xfffffe08
.p2align 12
P1_q:
    s_waitcnt vmcnt(8)
    s_barrier
    ds_read_b64_tr_b16 v[32:33], v182 offset:0
    ds_read_b64_tr_b16 v[34:35], v182 offset:512
    ds_read_b128 v[36:39], v196 offset:0
    ds_read_b64_tr_b16 v[40:41], v182 offset:2048
    ds_read_b64_tr_b16 v[42:43], v182 offset:2560
    ds_read_b128 v[44:47], v197 offset:0
    ds_read_b64_tr_b16 v[48:49], v182 offset:4096
    ds_read_b64_tr_b16 v[50:51], v182 offset:4608
    ds_read_b128 v[52:55], v198 offset:0
    ds_read_b64_tr_b16 v[56:57], v182 offset:6144
    ds_read_b64_tr_b16 v[58:59], v182 offset:6656
    ds_read_b128 v[60:63], v199 offset:0
    ds_read_b128 v[188:191], v200 offset:0
    ds_read_b128 v[192:195], v201 offset:0
    s_lshl_b32 s49, s48, 7
    s_add_u32 s49, s49, s44
    s_add_u32 m0, s45, 3072
    s_mul_i32 s50, s48, 64*896
    buffer_load_dwordx4 v181, s[8:11], s49 offen lds
    s_add_u32 s49, s49, 8*896
    s_add_u32 m0, s45, 10240
    s_add_u32 s50, s50, s46
    buffer_load_dwordx4 v181, s[8:11], s49 offen lds
    s_add_u32 m0, s47, 24576
    s_add_u32 s48, s48, 1
    buffer_load_dwordx4 v180, s[12:15], s50 offen lds
    s_add_u32 s50, s50, 8*896
    s_add_u32 m0, s47, 25600
    s_cmp_eq_u32 s48, 7
    s_cselect_b32 s48, 0, s48
    buffer_load_dwordx4 v180, s[12:15], s50 offen lds
    s_mov_b64 exec, s[54:55]
    global_store_byte v166, v167, s[92:93] offset:0 sc0 sc1
    s_mov_b64 exec, -1
    v_xor_b32 v184, v0, v176
    v_and_b32 v184, 1, v184
    v_mov_b32 v128, 0x3f803f80
    v_cmp_eq_u32 vcc, 0, v184
    v_mov_b32 v129, v128
    v_mov_b32 v130, v128
    v_mov_b32 v131, v128
    v_cndmask_b32 v124, 0, v128, vcc
    v_cndmask_b32 v125, 0, v128, vcc
    v_cndmask_b32 v126, 0, v128, vcc
    v_cndmask_b32 v127, 0, v128, vcc
    s_mov_b32 s16, s94
    s_mov_b32 s17, s95
    s_mov_b32 s18, 0x1d00000
    s_mov_b32 s19, 0x20000
    s_lshl_b32 s52, s4, 3
    s_lshl_b32 s53, s7, 2
    s_add_u32 s52, s52, s53
    s_lshl_b32 s68, s52, 13
    s_waitcnt vmcnt(8)
    s_barrier
    s_waitcnt lgkmcnt(0)
    v_mfma_f32_16x16x32_bf16 v[116:119], v[188:191], v[128:131], 0
    ds_read_b64_tr_b16 v[64:65], v182 offset:8192
    ds_read_b64_tr_b16 v[66:67], v182 offset:8704
    v_mfma_f32_16x16x32_bf16 v[120:123], v[188:191], v[188:191], 0
    ds_read_b128 v[68:71], v196 offset:1024
    ds_read_b64_tr_b16 v[72:73], v182 offset:10240
    v_mfma_f32_16x16x32_bf16 v[116:119], v[192:195], v[128:131], v[116:119]
    ds_read_b64_tr_b16 v[74:75], v182 offset:10752
    ds_read_b128 v[76:79], v197 offset:1024
    v_mfma_f32_16x16x32_bf16 v[120:123], v[192:195], v[192:195], v[120:123]
    ds_read_b64_tr_b16 v[80:81], v182 offset:12288
    ds_read_b64_tr_b16 v[82:83], v182 offset:12800
    v_mfma_f32_32x32x16_bf16 v[96:111], v[32:35], v[36:39], 0
    ds_read_b128 v[84:87], v198 offset:1024
    ds_read_b64_tr_b16 v[88:89], v182 offset:14336
    v_mfma_f32_16x16x32_bf16 v[112:115], v[32:35], v[124:127], 0
    ds_read_b64_tr_b16 v[90:91], v182 offset:14848
    ds_read_b128 v[92:95], v199 offset:1024
    v_mfma_f32_32x32x16_bf16 v[96:111], v[40:43], v[44:47], v[96:111]
    ds_read_b128 v[188:191], v200 offset:1024
    s_lshl_b32 s49, s48, 7
    s_add_u32 s49, s49, s44
    s_add_u32 m0, s45, 4096
    s_mul_i32 s50, s48, 64*896
    buffer_load_dwordx4 v181, s[8:11], s49 offen lds
    v_lshrrev_b32 v183, 3, v5
    v_lshlrev_b32 v183, 13, v183
    v_lshl_add_u32 v183, v179, 4, v183
    v_mov_b32 v212, -1
    v_mov_b32 v213, -1
    v_mfma_f32_16x16x32_bf16 v[112:115], v[40:43], v[124:127], v[112:115]
    s_add_u32 s49, s49, 8*896
    s_add_u32 m0, s45, 11264
    s_add_u32 s50, s50, s46
    buffer_load_dwordx4 v181, s[8:11], s49 offen lds
    v_mad_i32_i24 v132, v2, s25, v183
    v_mad_i32_i24 v133, v2, s27, v183
    v_mad_i32_i24 v134, v2, s29, v183
    v_mad_i32_i24 v135, v2, s31, v183
    v_mfma_f32_32x32x16_bf16 v[96:111], v[48:51], v[52:55], v[96:111]
    ds_read_b128 v[192:195], v201 offset:1024
    s_add_u32 m0, s47, 32768
    s_add_u32 s48, s48, 1
    buffer_load_dwordx4 v180, s[12:15], s50 offen lds
    v_add_u32 v132, s24, v132
    v_add_u32 v133, s26, v133
    v_add_u32 v134, s28, v134
    v_add_u32 v135, s30, v135
    v_mfma_f32_16x16x32_bf16 v[112:115], v[48:51], v[124:127], v[112:115]
    s_add_u32 s50, s50, 8*896
    s_add_u32 m0, s47, 33792
    s_cmp_eq_u32 s48, 7
    s_cselect_b32 s48, 0, s48
    buffer_load_dwordx4 v180, s[12:15], s50 offen lds
    s_movk_i32 s60, 896
    s_mov_b32 s22, 1605632
    s_mov_b32 s23, 0x20000
    s_mov_b32 s34, 29696
    s_mov_b32 s35, 3145728
    v_mfma_f32_32x32x16_bf16 v[96:111], v[56:59], v[60:63], v[96:111]
    s_movk_i32 s61, 256
    s_movk_i32 s62, 2341
    s_lshl_b32 s59, s2, 2
    s_add_u32 s59, s59, s3
    s_lshl_b32 s59, s59, 1
    v_mfma_f32_16x16x32_bf16 v[112:115], v[56:59], v[124:127], v[112:115]
    s_cmp_lt_u32 s2, 130
    s_cselect_b32 s60, 3584, s60
    s_cselect_b32 s61, s61, 256 + 784
    s_cselect_b32 s62, s62, 586
    s_cselect_b32 s63, 28, 112
    s_waitcnt vmcnt(8)
    s_barrier
    s_waitcnt lgkmcnt(0)
    v_mfma_f32_16x16x32_bf16 v[116:119], v[188:191], v[128:131], v[116:119]
    ds_read_b64_tr_b16 v[32:33], v182 offset:16384
    ds_read_b64_tr_b16 v[34:35], v182 offset:16896
    v_mfma_f32_16x16x32_bf16 v[120:123], v[188:191], v[188:191], v[120:123]
    ds_read_b128 v[36:39], v196 offset:2048
    ds_read_b64_tr_b16 v[40:41], v182 offset:18432
    v_mfma_f32_16x16x32_bf16 v[116:119], v[192:195], v[128:131], v[116:119]
    ds_read_b64_tr_b16 v[42:43], v182 offset:18944
    ds_read_b128 v[44:47], v197 offset:2048
    v_mfma_f32_16x16x32_bf16 v[120:123], v[192:195], v[192:195], v[120:123]
    ds_read_b64_tr_b16 v[48:49], v182 offset:20480
    ds_read_b64_tr_b16 v[50:51], v182 offset:20992
    v_mfma_f32_32x32x16_bf16 v[96:111], v[64:67], v[68:71], v[96:111]
    ds_read_b128 v[52:55], v198 offset:2048
    ds_read_b64_tr_b16 v[56:57], v182 offset:22528
    v_mfma_f32_16x16x32_bf16 v[112:115], v[64:67], v[124:127], v[112:115]
    ds_read_b64_tr_b16 v[58:59], v182 offset:23040
    ds_read_b128 v[60:63], v199 offset:2048
    v_mfma_f32_32x32x16_bf16 v[96:111], v[72:75], v[76:79], v[96:111]
    ds_read_b128 v[188:191], v200 offset:2048
    s_lshl_b32 s49, s48, 7
    s_add_u32 s49, s49, s44
    s_add_u32 m0, s45, 5120
    s_mul_i32 s50, s48, 64*896
    buffer_load_dwordx4 v181, s[8:11], s49 offen lds
    s_cmp_lt_u32 s2, 130
    s_cselect_b32 s57, 0, 1
    s_cselect_b32 s20, s36, s40
    s_cselect_b32 s21, s37, s41
    s_cselect_b32 s34, s34, 112*1024
    s_cselect_b32 s35, s35, 5242880
    v_mfma_f32_16x16x32_bf16 v[112:115], v[72:75], v[124:127], v[112:115]
    s_add_u32 s49, s49, 8*896
    s_add_u32 m0, s45, 12288
    s_add_u32 s50, s50, s46
    buffer_load_dwordx4 v181, s[8:11], s49 offen lds
    s_cmp_lt_u32 s2, 228
    s_cselect_b32 s61, s61, 256 + 1568
    s_cselect_b32 s62, s62, 2048
    s_cselect_b32 s63, s63, 32
    s_cselect_b32 s57, s57, 2
    s_cselect_b32 s56, 16, 14
    v_mfma_f32_32x32x16_bf16 v[96:111], v[80:83], v[84:87], v[96:111]
    ds_read_b128 v[192:195], v201 offset:2048
    s_add_u32 m0, s47, 40960
    s_add_u32 s48, s48, 1
    buffer_load_dwordx4 v180, s[12:15], s50 offen lds
    s_cmp_lt_u32 s2, 228
    s_cselect_b32 s20, s20, s32
    s_cselect_b32 s21, s21, s33
    s_cselect_b32 s22, s22, 401408
    s_cselect_b32 s34, s34, 32768
    s_cselect_b32 s35, s35, 2490368
    v_mfma_f32_16x16x32_bf16 v[112:115], v[80:83], v[124:127], v[112:115]
    s_add_u32 s50, s50, 8*896
    s_add_u32 m0, s47, 41984
    s_cmp_eq_u32 s48, 7
    s_cselect_b32 s48, 0, s48
    buffer_load_dwordx4 v180, s[12:15], s50 offen lds
    v_mfma_f32_32x32x16_bf16 v[96:111], v[88:91], v[92:95], v[96:111]
    s_sub_u32 s59, s59, s61
    s_mul_i32 s58, s59, s62
    s_lshr_b32 s58, s58, 16
    s_mul_i32 s53, s63, s58
    s_sub_u32 s59, s59, s53
    v_mfma_f32_16x16x32_bf16 v[112:115], v[88:91], v[124:127], v[112:115]
    s_mul_i32 s61, s59, s56
    s_mul_i32 s61, s61, s60
    s_lshl_b32 s64, s58, 7
    s_add_u32 s61, s61, s64
    v_mad_u32_u24 v136, v178, s60, v186
    s_lshl_b32 s60, s60, 3
    s_waitcnt vmcnt(8)
    s_barrier
    s_waitcnt lgkmcnt(0)
    v_mfma_f32_16x16x32_bf16 v[116:119], v[188:191], v[128:131], v[116:119]
    ds_read_b64_tr_b16 v[64:65], v182 offset:24576
    ds_read_b64_tr_b16 v[66:67], v182 offset:25088
    v_mfma_f32_16x16x32_bf16 v[120:123], v[188:191], v[188:191], v[120:123]
    ds_read_b128 v[68:71], v196 offset:3072
    ds_read_b64_tr_b16 v[72:73], v182 offset:26624
    v_mfma_f32_16x16x32_bf16 v[116:119], v[192:195], v[128:131], v[116:119]
    ds_read_b64_tr_b16 v[74:75], v182 offset:27136
    ds_read_b128 v[76:79], v197 offset:3072
    v_mfma_f32_16x16x32_bf16 v[120:123], v[192:195], v[192:195], v[120:123]
    ds_read_b64_tr_b16 v[80:81], v182 offset:28672
    ds_read_b64_tr_b16 v[82:83], v182 offset:29184
    v_mfma_f32_32x32x16_bf16 v[96:111], v[32:35], v[36:39], v[96:111]
    ds_read_b128 v[84:87], v198 offset:3072
    ds_read_b64_tr_b16 v[88:89], v182 offset:30720
    v_mfma_f32_16x16x32_bf16 v[112:115], v[32:35], v[124:127], v[112:115]
    ds_read_b64_tr_b16 v[90:91], v182 offset:31232
    ds_read_b128 v[92:95], v199 offset:3072
    v_mfma_f32_32x32x16_bf16 v[96:111], v[40:43], v[44:47], v[96:111]
    ds_read_b128 v[188:191], v200 offset:3072
    s_lshl_b32 s49, s48, 7
    s_add_u32 s49, s49, s44
    s_add_u32 m0, s45, 6144
    s_mul_i32 s50, s48, 64*896
    buffer_load_dwordx4 v181, s[8:11], s49 offen lds
    s_lshl_b32 s65, s3, 12
    s_add_u32 s65, s65, 114688
    s_mov_b32 s36, s38
    s_mov_b32 s37, s39
    s_movk_i32 s38, 3584
    s_mov_b32 s39, 0x20000
    v_lshlrev_b32 v138, 1, v0
    v_mfma_f32_16x16x32_bf16 v[112:115], v[40:43], v[124:127], v[112:115]
    s_add_u32 s49, s49, 8*896
    s_add_u32 m0, s45, 13312
    s_add_u32 s50, s50, s46
    buffer_load_dwordx4 v181, s[8:11], s49 offen lds
    s_lshl_b32 s52, s4, 12
    s_add_u32 s52, s52, 2359296
    s_add_u32 s66, s94, s52
    s_addc_u32 s67, s95, 0
    v_mfma_f32_32x32x16_bf16 v[96:111], v[48:51], v[52:55], v[96:111]
    ds_read_b128 v[192:195], v201 offset:3072
    s_add_u32 m0, s47, 49152
    s_add_u32 s48, s48, 1
    buffer_load_dwordx4 v180, s[12:15], s50 offen lds
    v_and_b32 v142, 1, v0
    v_lshlrev_b32 v142, 7, v142
    s_getreg_b32 s69, hwreg(HW_REG_XCC_ID, 0, 4)
    s_or_b32 s69, s69, 16
    v_mfma_f32_16x16x32_bf16 v[112:115], v[48:51], v[124:127], v[112:115]
    s_add_u32 s50, s50, 8*896
    s_add_u32 m0, s47, 50176
    s_cmp_eq_u32 s48, 7
    s_cselect_b32 s48, 0, s48
    buffer_load_dwordx4 v180, s[12:15], s50 offen lds
    s_lshl_b32 s53, s59, 10
    s_add_u32 s88, s35, s53
    s_mul_i32 s53, s34, s58
    s_lshl_b32 s53, s53, 1
    s_add_u32 s88, s88, s53
    s_add_u32 s89, s88, s34
    v_mfma_f32_32x32x16_bf16 v[96:111], v[56:59], v[60:63], v[96:111]
    v_lshl_add_u32 v139, v2, 2, v177
    v_lshlrev_b32 v139, 7, v139
    v_lshrrev_b32 v184, 1, v177
    v_lshl_add_u32 v139, v184, 6, v139
    v_mfma_f32_16x16x32_bf16 v[112:115], v[56:59], v[124:127], v[112:115]
    v_lshl_add_u32 v139, v176, 5, v139
    v_lshl_add_u32 v139, v6, 3, v139
    v_add_u32 v139, s65, v139
    v_xor_b32 v140, 64, v139
    s_waitcnt vmcnt(8)
    s_barrier
    s_waitcnt lgkmcnt(0)
    v_mfma_f32_16x16x32_bf16 v[116:119], v[188:191], v[128:131], v[116:119]
    ds_read_b64_tr_b16 v[32:33], v182 offset:32768
    ds_read_b64_tr_b16 v[34:35], v182 offset:33280
    v_mfma_f32_16x16x32_bf16 v[120:123], v[188:191], v[188:191], v[120:123]
    ds_read_b128 v[36:39], v196 offset:4096
    ds_read_b64_tr_b16 v[40:41], v182 offset:34816
    v_mfma_f32_16x16x32_bf16 v[116:119], v[192:195], v[128:131], v[116:119]
    ds_read_b64_tr_b16 v[42:43], v182 offset:35328
    ds_read_b128 v[44:47], v197 offset:4096
    v_mfma_f32_16x16x32_bf16 v[120:123], v[192:195], v[192:195], v[120:123]
    ds_read_b64_tr_b16 v[48:49], v182 offset:36864
    ds_read_b64_tr_b16 v[50:51], v182 offset:37376
    v_mfma_f32_32x32x16_bf16 v[96:111], v[64:67], v[68:71], v[96:111]
    ds_read_b128 v[52:55], v198 offset:4096
    ds_read_b64_tr_b16 v[56:57], v182 offset:38912
    v_mfma_f32_16x16x32_bf16 v[112:115], v[64:67], v[124:127], v[112:115]
    ds_read_b64_tr_b16 v[58:59], v182 offset:39424
    ds_read_b128 v[60:63], v199 offset:4096
    v_mfma_f32_32x32x16_bf16 v[96:111], v[72:75], v[76:79], v[96:111]
    ds_read_b128 v[188:191], v200 offset:4096
    buffer_store_dwordx2 v[212:213], v132, s[16:19], s68 offen
    s_add_u32 s62, s59, 2
    s_lshr_b32 s62, s62, 3
    s_mul_i32 s71, s58, 59392
    s_lshr_b32 s52, s62, 1
    s_lshl_b32 s52, s52, 9
    s_add_u32 s71, s71, s52
    v_mfma_f32_16x16x32_bf16 v[112:115], v[72:75], v[124:127], v[112:115]
    buffer_store_dwordx2 v[212:213], v133, s[16:19], s68 offen
    s_and_b32 s52, s62, 1
    s_lshl_b32 s52, s52, 3
    s_add_u32 s71, s71, s52
    s_add_u32 s71, s71, 3174400
    s_cmp_lt_u32 s62, 2
    s_cselect_b32 s70, 0xffff0000, 0
    v_mfma_f32_32x32x16_bf16 v[96:111], v[80:83], v[84:87], v[96:111]
    ds_read_b128 v[192:195], v201 offset:4096
    buffer_store_dwordx2 v[212:213], v134, s[16:19], s68 offen
    s_lshl_b32 s52, s3, 5
    s_add_u32 s52, s52, s59
    s_cmp_eq_u32 s52, 32 + 26
    s_cselect_b32 s91, 0, -1
    s_cmp_eq_u32 s52, 96 + 2
    s_cselect_b32 s90, 0, -1
    s_cselect_b32 s52, 1, s3
    s_lshl_b32 s53, s57, 2
    s_or_b32 s52, s52, s53
    s_cmp_eq_u32 s52, 1
    s_cselect_b32 s52, 0, 0x80000000
    v_mul_u32_u24 v164, 29696, v2
    v_lshl_add_u32 v164, v5, 4, v164
    v_or_b32 v164, s52, v164
    v_mfma_f32_16x16x32_bf16 v[112:115], v[80:83], v[124:127], v[112:115]
    buffer_store_dwordx2 v[212:213], v135, s[16:19], s68 offen
    v_mfma_f32_32x32x16_bf16 v[96:111], v[88:91], v[92:95], v[96:111]
    s_cmp_eq_u32 s57, 2
    s_cselect_b32 s52, 0, -1
    v_add_u32 v143, -1, v2
    v_or_b32 v143, s52, v143
    v_mfma_f32_16x16x32_bf16 v[112:115], v[88:91], v[124:127], v[112:115]
    global_load_dword v137, v142, s[92:93] offset:0 sc1
    s_waitcnt vmcnt(9)
    s_barrier
    s_waitcnt lgkmcnt(0)
    v_mfma_f32_16x16x32_bf16 v[116:119], v[188:191], v[128:131], v[116:119]
    ds_read_b64_tr_b16 v[64:65], v182 offset:40960
    ds_read_b64_tr_b16 v[66:67], v182 offset:41472
    v_mfma_f32_16x16x32_bf16 v[120:123], v[188:191], v[188:191], v[120:123]
    ds_read_b128 v[68:71], v196 offset:5120
    ds_read_b64_tr_b16 v[72:73], v182 offset:43008
    v_mfma_f32_16x16x32_bf16 v[116:119], v[192:195], v[128:131], v[116:119]
    ds_read_b64_tr_b16 v[74:75], v182 offset:43520
    ds_read_b128 v[76:79], v197 offset:5120
    v_mfma_f32_16x16x32_bf16 v[120:123], v[192:195], v[192:195], v[120:123]
    ds_read_b64_tr_b16 v[80:81], v182 offset:45056
    ds_read_b64_tr_b16 v[82:83], v182 offset:45568
    v_mfma_f32_32x32x16_bf16 v[96:111], v[32:35], v[36:39], v[96:111]
    ds_read_b128 v[84:87], v198 offset:5120
    ds_read_b64_tr_b16 v[88:89], v182 offset:47104
    v_mfma_f32_16x16x32_bf16 v[112:115], v[32:35], v[124:127], v[112:115]
    ds_read_b64_tr_b16 v[90:91], v182 offset:47616
    ds_read_b128 v[92:95], v199 offset:5120
    v_mfma_f32_32x32x16_bf16 v[96:111], v[40:43], v[44:47], v[96:111]
    ds_read_b128 v[188:191], v200 offset:5120
    s_add_u32 m0, s65, 0
    s_nop 0
    buffer_load_dwordx4 v136, s[20:23], s61 offen lds
    s_mov_b32 s24, s94
    s_mov_b32 s25, s95
    s_mov_b32 s26, 0x1d00000
    s_mov_b32 s27, 0x20000
    v_mfma_f32_16x16x32_bf16 v[112:115], v[40:43], v[124:127], v[112:115]
    s_add_u32 m0, s65, 1024
    s_add_u32 s61, s61, s60
    buffer_load_dwordx4 v136, s[20:23], s61 offen lds
    s_lshl_b32 s52, s3, 7
    s_add_u32 s53, s52, 131072
    v_and_b32 v184, 15, v0
    v_lshl_add_u32 v170, v184, 3, s53
    v_lshrrev_b32 v185, 4, v0
    v_cmp_eq_u32 vcc, v185, v177
    v_lshlrev_b32 v173, 3, v0
    v_add_u32 v173, 133120, v173
    v_cndmask_b32 v170, v173, v170, vcc
    s_add_u32 s52, s52, 131584
    v_lshlrev_b32 v185, 4, v185
    v_lshl_add_u32 v185, v184, 6, v185
    v_add_u32 v185, s52, v185
    v_cmp_gt_u32 vcc, 2, v184
    v_lshl_add_u32 v172, v2, 4, s52
    v_add_u32 v171, 133632, v1
    v_cndmask_b32 v171, v171, v185, vcc
    v_mfma_f32_32x32x16_bf16 v[96:111], v[48:51], v[52:55], v[96:111]
    ds_read_b128 v[192:195], v201 offset:5120
    s_add_u32 m0, s65, 2048
    s_add_u32 s61, s61, s60
    buffer_load_dwordx4 v136, s[20:23], s61 offen lds
    v_mfma_f32_16x16x32_bf16 v[112:115], v[48:51], v[124:127], v[112:115]
    s_lshl_b32 s52, s7, 8
    s_add_u32 s52, s52, 131072
    v_lshl_add_u32 v173, v5, 3, s52
    v_and_b32 v184, 1, v0
    v_cmp_ne_u32 s[0:1], 0, v184
    v_mfma_f32_32x32x16_bf16 v[96:111], v[56:59], v[60:63], v[96:111]
    s_add_u32 m0, s65, 3072
    s_add_u32 s61, s61, s60
    buffer_load_dwordx4 v136, s[20:23], s61 offen lds
    v_mfma_f32_16x16x32_bf16 v[112:115], v[56:59], v[124:127], v[112:115]
    buffer_load_ushort v138, v138, s[36:39], s64 offen
    s_waitcnt vmcnt(10)
    s_barrier
    s_waitcnt lgkmcnt(0)
    v_mfma_f32_16x16x32_bf16 v[116:119], v[188:191], v[128:131], v[116:119]
    ds_read_b64_tr_b16 v[32:33], v182 offset:49152
    ds_read_b64_tr_b16 v[34:35], v182 offset:49664
    v_mfma_f32_16x16x32_bf16 v[120:123], v[188:191], v[188:191], v[120:123]
    ds_read_b128 v[36:39], v196 offset:6144
    ds_read_b64_tr_b16 v[40:41], v182 offset:51200
    v_mfma_f32_16x16x32_bf16 v[116:119], v[192:195], v[128:131], v[116:119]
    ds_read_b64_tr_b16 v[42:43], v182 offset:51712
    ds_read_b128 v[44:47], v197 offset:6144
    v_mfma_f32_16x16x32_bf16 v[120:123], v[192:195], v[192:195], v[120:123]
    ds_read_b64_tr_b16 v[48:49], v182 offset:53248
    ds_read_b64_tr_b16 v[50:51], v182 offset:53760
    v_mfma_f32_32x32x16_bf16 v[96:111], v[64:67], v[68:71], v[96:111]
    ds_read_b128 v[52:55], v198 offset:6144
    v_mfma_f32_16x16x32_bf16 v[112:115], v[64:67], v[124:127], v[112:115]
    ds_read_b64_tr_b16 v[56:57], v182 offset:55296
    v_mfma_f32_32x32x16_bf16 v[96:111], v[72:75], v[76:79], v[96:111]
    ds_read_b128 v[188:191], v200 offset:6144
    ds_read_b64_tr_b16 v[58:59], v182 offset:55808
    v_mfma_f32_16x16x32_bf16 v[112:115], v[72:75], v[124:127], v[112:115]
    ds_read_b128 v[60:63], v199 offset:6144
    v_mfma_f32_32x32x16_bf16 v[96:111], v[80:83], v[84:87], v[96:111]
    ds_read_b128 v[192:195], v201 offset:6144
    s_lshl_b32 s52, s3, 8
    s_add_u32 s52, s52, 132096
    v_lshlrev_b32 v175, 2, v0
    v_add_u32 v174, s52, v175
    v_add_u32 v175, 132096, v175
    v_mfma_f32_16x16x32_bf16 v[112:115], v[80:83], v[124:127], v[112:115]
    s_lshl_b32 s53, s5, 2
    s_add_u32 s53, s53, s3
    v_mov_b32 v16, s53
    v_mov_b32 v17, s69
    s_mul_i32 s69, s69, 0x01010101
    v_lshlrev_b32 v30, 2, v179
    v_mfma_f32_32x32x16_bf16 v[96:111], v[88:91], v[92:95], v[96:111]
    s_and_b32 s52, s2, 7
    s_lshl_b32 s53, s52, 7
    s_lshl_b32 s52, s3, 12
    s_add_u32 s53, s53, s52
    s_add_u32 s53, s53, 2360320
    v_lshl_add_u32 v31, v179, 14, s53
    v_mfma_f32_16x16x32_bf16 v[112:115], v[88:91], v[124:127], v[112:115]
    s_and_b32 s52, s4, 28
    s_add_u32 s52, s52, s3
    s_lshl_b32 s52, s52, 12
    s_add_u32 s52, s52, 2359296
    s_lshl_b32 s53, s4, 12
    s_add_u32 s53, s53, 2359296
    v_and_b32 v184, 8, v0
    v_cmp_eq_u32 vcc, 0, v184
    v_add_u32 v28, s53, v30
    v_mov_b32 v184, s52
    v_cndmask_b32 v28, v184, v28, vcc
    s_waitcnt lgkmcnt(0)
    v_mfma_f32_16x16x32_bf16 v[116:119], v[188:191], v[128:131], v[116:119]
    s_mov_b32 s10, s8
    s_mov_b32 s11, s9
    s_mov_b32 s8, s94
    s_mov_b32 s9, s95
    s_mov_b32 s12, s42
    s_mov_b32 s13, s43
    v_mfma_f32_16x16x32_bf16 v[120:123], v[188:191], v[188:191], v[120:123]
    s_mov_b32 s14, s6
    s_mov_b32 s15, s7
    s_min_u32 s28, s5, 6
    s_lshl_b32 s6, s4, 3
    s_add_u32 s6, s6, s5
    s_lshl_b32 s29, s4, 16
    v_mfma_f32_16x16x32_bf16 v[116:119], v[192:195], v[128:131], v[116:119]
    s_lshl_b32 s52, s6, 13
    v_add_u32 v18, s52, v1
    s_and_b32 s52, s4, 28
    s_add_u32 s52, s52, s3
    s_lshl_b32 s52, s52, 13
    s_add_u32 s52, s52, 4853760
    s_add_u32 s32, s8, s52
    s_addc_u32 s33, s9, 0
    v_mfma_f32_16x16x32_bf16 v[120:123], v[192:195], v[192:195], v[120:123]
    v_cmp_ne_u32 s[64:65], 0, v2
    v_cmp_lt_u32 s[62:63], 1, v6
    v_mfma_f32_32x32x16_bf16 v[96:111], v[32:35], v[36:39], v[96:111]
    s_add_u32 s58, s3, 1
    s_and_b32 s58, s58, 3
    s_lshl_b32 s58, s58, 11
    s_add_u32 s59, s58, 2048
    s_and_b32 s59, s59, 0x1800
    s_add_u32 s60, s59, 2048
    s_and_b32 s60, s60, 0x1800
    s_add_u32 s61, s60, 2048
    s_and_b32 s61, s61, 0x1800
    v_mfma_f32_16x16x32_bf16 v[112:115], v[32:35], v[124:127], v[112:115]
    v_mfma_f32_32x32x16_bf16 v[96:111], v[40:43], v[44:47], v[96:111]
    v_mfma_f32_16x16x32_bf16 v[112:115], v[40:43], v[124:127], v[112:115]
    v_mfma_f32_32x32x16_bf16 v[96:111], v[48:51], v[52:55], v[96:111]
    v_mfma_f32_16x16x32_bf16 v[112:115], v[48:51], v[124:127], v[112:115]
    v_mfma_f32_32x32x16_bf16 v[96:111], v[56:59], v[60:63], v[96:111]
    v_mfma_f32_16x16x32_bf16 v[112:115], v[56:59], v[124:127], v[112:115]
    s_waitcnt vmcnt(5)
    v_cmp_ne_u32 vcc, 0x01010101, v137
    v_cndmask_b32 v116, v116, v117, s[0:1]
    v_cndmask_b32 v118, v118, v119, s[0:1]
    v_cndmask_b32 v120, v120, v121, s[0:1]
    v_cndmask_b32 v122, v122, v123, s[0:1]
    s_cbranch_vccnz P1_ack_q
P1_ack_q_done:
    s_mov_b64 exec, 1
    global_store_byte v16, v17, s[66:67] offset:512
    s_mov_b64 exec, -1
    v_cndmask_b32 v116, v116, v118, s[62:63]
    v_cndmask_b32 v120, v120, v122, s[62:63]
    v_mul_f32 v202, 0x3b124925, v116
    v_mul_f32 v204, 0x3b124925, v120
    v_fma_f32 v204, -v202, v202, v204
    v_max_f32 v204, 0, v204
    v_add_f32 v204, 0x3727c5ac, v204
    v_rsq_f32 v204, v204
    ds_write_b128 v171, v[112:115]
    v_mul_f32 v205, -v202, v204
    ds_write_b64 v170, v[204:205]
    ds_read_b128 v[32:35], v172 offset:0
    ds_read_b128 v[36:39], v172 offset:32
    ds_read_b128 v[40:43], v172 offset:64
    ds_read_b128 v[44:47], v172 offset:96
    s_waitcnt lgkmcnt(0)
    s_barrier
    ds_read_b64 v[202:203], v173
    s_waitcnt lgkmcnt(0)
    v_mul_f32 v202, 0x3e8b97f6, v202
    v_mul_f32 v203, 0x3e8b97f6, v203
    v_mul_f32 v96, v96, v202
    v_fmac_f32 v96, v32, v203
    v_mul_f32 v97, v97, v202
    v_fmac_f32 v97, v33, v203
    v_mul_f32 v98, v98, v202
    v_fmac_f32 v98, v34, v203
    v_mul_f32 v99, v99, v202
    v_fmac_f32 v99, v35, v203
    v_cvt_pk_bf16_f32 v112, v96, v97
    v_cvt_pk_bf16_f32 v113, v98, v99
    buffer_store_dwordx2 v[112:113], v132, s[16:19], s68 offen
    v_mul_f32 v100, v100, v202
    v_fmac_f32 v100, v36, v203
    v_mul_f32 v101, v101, v202
    v_fmac_f32 v101, v37, v203
    v_mul_f32 v102, v102, v202
    v_fmac_f32 v102, v38, v203
    v_mul_f32 v103, v103, v202
    v_fmac_f32 v103, v39, v203
    v_cvt_pk_bf16_f32 v114, v100, v101
    v_cvt_pk_bf16_f32 v115, v102, v103
    buffer_store_dwordx2 v[114:115], v133, s[16:19], s68 offen
    v_mul_f32 v104, v104, v202
    v_fmac_f32 v104, v40, v203
    v_mul_f32 v105, v105, v202
    v_fmac_f32 v105, v41, v203
    v_mul_f32 v106, v106, v202
    v_fmac_f32 v106, v42, v203
    v_mul_f32 v107, v107, v202
    v_fmac_f32 v107, v43, v203
    v_cvt_pk_bf16_f32 v116, v104, v105
    v_cvt_pk_bf16_f32 v117, v106, v107
    buffer_store_dwordx2 v[116:117], v134, s[16:19], s68 offen
    v_mul_f32 v108, v108, v202
    v_fmac_f32 v108, v44, v203
    v_mul_f32 v109, v109, v202
    v_fmac_f32 v109, v45, v203
    v_mul_f32 v110, v110, v202
    v_fmac_f32 v110, v46, v203
    v_mul_f32 v111, v111, v202
    v_fmac_f32 v111, v47, v203
    v_cvt_pk_bf16_f32 v118, v108, v109
    v_cvt_pk_bf16_f32 v119, v110, v111
    buffer_store_dwordx2 v[118:119], v135, s[16:19], s68 offen
P1_join:
    s_cmp_eq_u32 s3, 0
    s_cbranch_scc1 KA_t1
    s_cmp_eq_u32 s3, 1
    s_cbranch_scc1 KA_t2
    s_cmp_eq_u32 s3, 2
    s_cbranch_scc1 KA_t3
    s_branch KA_tret
.fill 624, 4, 0xbf800000
KA_tret:
    v_add_u32 v7, 8192, v1
    v_add_u32 v9, 16384, v1
    v_add_u32 v8, 24576, v1
    s_lshl_b32 s52, s3, 13
    s_add_u32 s52, s52, 2097152
    v_add_u32 v22, s52, v1
    v_add_u32 v23, 4096, v22
    v_lshrrev_b32 v184, 2, v5
    v_mul_u32_u24 v3, 7168, v184
    v_mul_u32_u24 v184, 896, v6
    v_add_u32 v3, v3, v184
    v_lshl_add_u32 v3, v2, 4, v3
    v_lshrrev_b32 v184, 3, v5
    v_lshlrev_b32 v24, 11, v184
    v_bfe_u32 v184, v5, 2, 1
    v_lshl_add_u32 v24, v184, 15, v24
    v_lshl_add_u32 v24, v2, 9, v24
    v_lshl_add_u32 v24, v6, 4, v24
    v_and_b32 v184, 1, v0
    v_lshl_add_u32 v25, v184, 10, v24
    v_lshrrev_b32 v20, 1, v0
    v_lshlrev_b32 v20, 12, v20
    v_and_b32 v184, 16, v1
    v_add_u32 v20, v184, v20
    v_add_u32 v20, 2359296, v20
    v_lshrrev_b32 v10, 2, v0
    v_lshlrev_b32 v10, 7, v10
    v_lshl_add_u32 v10, v6, 2, v10
    v_add_u32 v11, 8192, v10
    s_lshl_b32 s53, s28, 16
    s_lshl_b32 s52, s14, 14
    s_add_u32 s53, s53, s52
    s_add_u32 s53, s53, 2494464
    s_lshl_b32 s52, s14, 15
    s_add_u32 s7, s53, s52
    s_add_u32 s50, s8, s7
    s_addc_u32 s51, s9, 0
    s_xor_b32 s52, s52, 0x8000
    s_add_u32 s7, s53, s52
    s_add_u32 s48, s8, s7
    s_addc_u32 s49, s9, 0
    global_load_dword v207, v28, s[8:9] offset:512 sc1
    global_load_dwordx4 v[64:67], v1, s[32:33] offset:-4096 sc1
    global_load_dwordx4 v[68:71], v1, s[32:33] offset:-3072 sc1
    global_load_dwordx4 v[72:75], v1, s[32:33] offset:-2048 sc1
    global_load_dwordx4 v[76:79], v1, s[32:33] offset:-1024 sc1
    global_load_dwordx4 v[80:83], v1, s[32:33] offset:0 sc1
    global_load_dwordx4 v[84:87], v1, s[32:33] offset:1024 sc1
    global_load_dwordx4 v[88:91], v1, s[32:33] offset:2048 sc1
    global_load_dwordx4 v[92:95], v1, s[32:33] offset:3072 sc1
    s_lshl_b32 s53, s28, 3
    s_add_u32 s53, s53, s3
    s_mul_i32 s53, s53, 29696
    s_add_u32 s53, s53, 3149824
    s_add_u32 s96, s8, s53
    s_addc_u32 s97, s9, 0
    s_add_u32 s98, s96, 118784
    s_addc_u32 s99, s97, 0
    s_lshl_b32 s53, s4, 4
    s_add_u32 s53, s53, s15
    s_mul_i32 s53, s53, 3584
    s_lshl_b32 s52, s28, 7
    s_add_u32 s53, s53, s52
    s_lshl_b32 s52, s14, 6
    s_add_u32 s53, s53, s52
    s_add_u32 s100, s10, s53
    s_addc_u32 s101, s11, 0
    s_add_u32 s53, s29, 9437184
    s_add_u32 s54, s8, s53
    s_addc_u32 s55, s9, 0
    s_lshl_b32 s53, s28, 1
    s_add_u32 s53, s53, s14
    s_mul_i32 s30, s15, 36864
    s_lshl_b32 s31, s53, 11
    s_add_u32 s30, s30, s31
    s_lshl_b32 s31, s15, 12
    s_lshl_b32 s53, s53, 8
    s_add_u32 s31, s31, s53
    s_add_u32 s31, s31, 28672
    v_add_u32 v26, s30, v1
    v_lshl_add_u32 v27, v5, 3, s31
    v_and_b32 v184, 15, v0
    v_lshl_add_u32 v12, v184, 7, s30
    v_and_b32 v184, 1, v0
    v_cmp_gt_u32 vcc, 16, v0
    v_lshl_add_u32 v184, v184, 7, s31
    s_nop 0
    v_cndmask_b32 v12, v184, v12, vcc
    s_mul_i32 s53, s58, 6
    s_add_u32 s53, s53, 0
    v_add_u32 v13, s53, v1
    s_mul_i32 s53, s59, 6
    s_add_u32 s53, s53, 4096
    v_add_u32 v14, s53, v1
    s_mul_i32 s53, s60, 6
    s_add_u32 s53, s53, 8192
    v_add_u32 v15, s53, v1
    s_mov_b32 s52, 0x17654321
    s_mov_b32 s53, 0x765432
    s_lshl_b32 s7, s28, 2
    s_lshr_b64 s[52:53], s[52:53], s7
    s_and_b32 s7, s2, 7
    s_mul_i32 s7, s7, 0x11111111
    s_xor_b32 s52, s52, s7
    s_bfe_u32 s34, s52, 0x30000
    s_lshl_b32 s34, s34, 15
    s_bfe_u32 s35, s52, 0x30004
    s_lshl_b32 s35, s35, 15
    s_bfe_u32 s36, s52, 0x30008
    s_lshl_b32 s36, s36, 15
    s_bfe_u32 s37, s52, 0x3000c
    s_lshl_b32 s37, s37, 15
    s_bfe_u32 s38, s52, 0x30010
    s_lshl_b32 s38, s38, 15
    s_bfe_u32 s39, s52, 0x30014
    s_lshl_b32 s39, s39, 15
    s_bfe_u32 s40, s52, 0x30018
    s_lshl_b32 s40, s40, 15
    global_load_dword v29, v28, s[8:9] offset:512 sc1
    buffer_load_dwordx4 v[32:35], v18, s[16:19], s58 offen offset:0 sc1
    buffer_load_dwordx4 v[36:39], v18, s[16:19], s58 offen offset:1024 sc1
    buffer_load_dwordx4 v[40:43], v18, s[16:19], s59 offen offset:0 sc1
    buffer_load_dwordx4 v[44:47], v18, s[16:19], s59 offen offset:1024 sc1
    buffer_load_dwordx4 v[48:51], v18, s[16:19], s60 offen offset:0 sc1
    buffer_load_dwordx4 v[52:55], v18, s[16:19], s60 offen offset:1024 sc1
    buffer_load_dwordx4 v[56:59], v18, s[16:19], s61 offen offset:0 sc1
    buffer_load_dwordx4 v[60:63], v18, s[16:19], s61 offen offset:1024 sc1
    s_waitcnt vmcnt(22)
    ds_read_b64_tr_b16 v[144:145], v139 offset:0
    ds_read_b64_tr_b16 v[146:147], v139 offset:1024
    ds_read_b64_tr_b16 v[148:149], v140 offset:0
    ds_read_b64_tr_b16 v[150:151], v140 offset:1024
    ds_read_b64_tr_b16 v[152:153], v139 offset:2048
    ds_read_b64_tr_b16 v[154:155], v139 offset:3072
    ds_read_b64_tr_b16 v[156:157], v140 offset:2048
    ds_read_b64_tr_b16 v[158:159], v140 offset:3072
    s_lshl_b32 s53, s3, 13
    s_lshl_b32 s52, s5, 6
    s_add_u32 s53, s53, s52
    s_add_u32 s53, s53, s29
    s_add_u32 s53, s53, 7340032
    s_add_u32 s20, s8, s53
    s_addc_u32 s21, s9, 0
    s_lshl_b32 s53, s15, 15
    s_lshl_b32 s52, s14, 14
    s_add_u32 s53, s53, s52
    s_add_u32 s53, s53, s29
    s_add_u32 s53, s53, 7344128
    s_add_u32 s22, s8, s53
    s_addc_u32 s23, s9, 0
    s_lshr_b32 s53, s2, 3
    s_lshl_b32 s53, s53, 2
    s_add_u32 s53, s53, s3
    s_min_u32 s52, s53, 55
    s_lshl_b32 s52, s52, 13
    s_add_u32 s52, s52, 2490368
    v_lshl_add_u32 v21, v0, 7, s52
    s_mul_i32 s53, s53, 13056
    s_add_u32 s53, s53, 3149824
    s_add_u32 s56, s8, s53
    s_addc_u32 s57, s9, 0
    v_lshlrev_b32 v165, 16, v138
    v_and_b32 v165, s70, v165
    s_waitcnt vmcnt(9)
    v_cmp_ne_u32 s[52:53], s69, v207
    v_max3_u32 v205, v64, v68, v72
    v_max3_u32 v206, v80, v84, v88
    s_and_b64 s[52:53], s[52:53], 0xff00
    v_max3_u32 v205, v205, v76, v92
    v_max_u32 v205, v205, v206
    v_cmp_eq_u32 vcc, -1, v205
    s_nop 0
    s_or_b64 vcc, vcc, s[52:53]
    s_cbranch_vccnz P1_again
P1_kvok:
    s_waitcnt lgkmcnt(0)
    v_and_b32 v154, v143, v154
    v_and_b32 v155, v143, v155
    v_and_b32 v158, v143, v158
    v_and_b32 v159, v143, v159
    v_mfma_f32_32x32x16_bf16 v[208:223], v[128:131], v[144:147], 0
    v_mfma_f32_32x32x16_bf16 v[224:239], v[128:131], v[148:151], 0
    v_mfma_f32_32x32x16_bf16 v[208:223], v[128:131], v[152:155], v[208:223]
    v_mfma_f32_32x32x16_bf16 v[224:239], v[128:131], v[156:159], v[224:239]
    global_load_dword v4, v31, s[8:9] sc1
    s_mov_b32 s7, 0
    s_waitcnt vmcnt(1)
P1_qchk:
    v_cmp_ne_u32 s[52:53], s69, v29
    v_cndmask_b32 v38, v38, 0, s[64:65]
    v_cndmask_b32 v39, v39, 0, s[64:65]
    v_cndmask_b32 v46, v46, 0, s[64:65]
    v_cndmask_b32 v47, v47, 0, s[64:65]
    v_cndmask_b32 v54, v54, 0, s[64:65]
    v_cndmask_b32 v55, v55, 0, s[64:65]
    v_cndmask_b32 v62, v62, 0, s[64:65]
    v_cndmask_b32 v63, v63, 0, s[64:65]
    v_max3_u32 v19, v32, v34, v36
    v_max3_u32 v29, v40, v42, v44
    v_mfma_f32_32x32x16_bf16 v[96:111], v[64:67], v[32:35], 0
    v_max3_u32 v19, v19, v48, v50
    v_max3_u32 v29, v29, v52, v56
    s_and_b64 s[52:53], s[52:53], 0xff
    v_max3_u32 v19, v19, v58, v60
    v_mfma_f32_32x32x16_bf16 v[96:111], v[68:71], v[36:39], v[96:111]
    v_max3_u32 v29, v29, v38, v46
    v_max3_u32 v19, v19, v54, v62
    v_max_u32 v19, v19, v29
    v_cmp_eq_u32 vcc, -1, v19
    s_mov_b64 s[0:1], -1
    s_or_b64 vcc, vcc, s[52:53]
    s_cbranch_vccnz P1_qagain
P1_ok:
    s_nop 5
    v_mfma_f32_32x32x16_bf16 v[112:127], v[64:67], v[40:43], 0
    v_exp_f32 v96, v96
    v_exp_f32 v97, v97
    v_exp_f32 v98, v98
    v_exp_f32 v99, v99
    v_cvt_pk_bf16_f32 v128, v96, v97
    v_mfma_f32_32x32x16_bf16 v[112:127], v[68:71], v[44:47], v[112:127]
    v_exp_f32 v100, v100
    v_cvt_pk_bf16_f32 v129, v98, v99
    v_exp_f32 v101, v101
    v_exp_f32 v102, v102
    v_exp_f32 v103, v103
    v_cvt_pk_bf16_f32 v130, v100, v101
    v_cndmask_b32 v160, v208, v224, s[64:65]
    ds_write_b32 v174, v160
    v_exp_f32 v104, v104
    v_cvt_pk_bf16_f32 v131, v102, v103
    v_exp_f32 v105, v105
    v_exp_f32 v106, v106
    v_exp_f32 v107, v107
    v_cvt_pk_bf16_f32 v132, v104, v105
    v_exp_f32 v108, v108
    v_cvt_pk_bf16_f32 v133, v106, v107
    v_exp_f32 v109, v109
    v_exp_f32 v110, v110
    v_exp_f32 v111, v111
    v_cvt_pk_bf16_f32 v134, v108, v109
    v_cvt_pk_bf16_f32 v135, v110, v111
    v_mfma_f32_32x32x16_bf16 v[96:111], v[64:67], v[48:51], 0
    v_exp_f32 v112, v112
    v_exp_f32 v113, v113
    v_exp_f32 v114, v114
    v_exp_f32 v115, v115
    v_cvt_pk_bf16_f32 v136, v112, v113
    v_mfma_f32_32x32x16_bf16 v[96:111], v[68:71], v[52:55], v[96:111]
    v_exp_f32 v116, v116
    v_cvt_pk_bf16_f32 v137, v114, v115
    v_exp_f32 v117, v117
    v_exp_f32 v118, v118
    v_exp_f32 v119, v119
    v_cvt_pk_bf16_f32 v138, v116, v117
    v_mfma_f32_32x32x16_bf16 a[0:15], v[72:75], v[128:131], 0
    s_waitcnt lgkmcnt(0)
    s_barrier
    ds_read_b32 v160, v175 offset:0
    ds_read_b32 v161, v175 offset:256
    ds_read_b32 v162, v175 offset:512
    ds_read_b32 v163, v175 offset:768
    v_exp_f32 v120, v120
    v_cvt_pk_bf16_f32 v139, v118, v119
    v_exp_f32 v121, v121
    v_exp_f32 v122, v122
    v_exp_f32 v123, v123
    v_cvt_pk_bf16_f32 v140, v120, v121
    v_mfma_f32_32x32x16_bf16 a[0:15], v[76:79], v[132:135], a[0:15]
    v_exp_f32 v124, v124
    v_cvt_pk_bf16_f32 v141, v122, v123
    v_exp_f32 v125, v125
    v_exp_f32 v126, v126
    v_exp_f32 v127, v127
    v_cvt_pk_bf16_f32 v142, v124, v125
    v_cvt_pk_bf16_f32 v143, v126, v127
    v_mfma_f32_32x32x16_bf16 v[112:127], v[64:67], v[56:59], 0
    s_waitcnt vmcnt(0)
    v_cmp_ne_u32 vcc, 0x01010101, v4
    s_cbranch_vccnz KB_rspin
KB_rspin_done:
    v_exp_f32 v96, v96
    v_exp_f32 v97, v97
    v_exp_f32 v98, v98
    v_exp_f32 v99, v99
    v_cvt_pk_bf16_f32 v128, v96, v97
    v_mfma_f32_32x32x16_bf16 v[112:127], v[68:71], v[60:63], v[112:127]
    buffer_load_dwordx4 v[240:243], v22, s[16:19], s34 offen offset:0
    v_exp_f32 v100, v100
    v_cvt_pk_bf16_f32 v129, v98, v99
    v_exp_f32 v101, v101
    v_exp_f32 v102, v102
    v_exp_f32 v103, v103
    v_cvt_pk_bf16_f32 v130, v100, v101
    v_mfma_f32_32x32x16_bf16 a[16:31], v[72:75], v[136:139], 0
    buffer_load_dwordx4 v[244:247], v22, s[16:19], s34 offen offset:1024
    v_exp_f32 v104, v104
    v_cvt_pk_bf16_f32 v131, v102, v103
    v_exp_f32 v105, v105
    v_exp_f32 v106, v106
    v_exp_f32 v107, v107
    v_cvt_pk_bf16_f32 v132, v104, v105
    v_mfma_f32_32x32x16_bf16 a[16:31], v[76:79], v[140:143], a[16:31]
    v_exp_f32 v108, v108
    v_cvt_pk_bf16_f32 v133, v106, v107
    v_exp_f32 v109, v109
    v_exp_f32 v110, v110
    v_exp_f32 v111, v111
    v_cvt_pk_bf16_f32 v134, v108, v109
    v_cvt_pk_bf16_f32 v135, v110, v111
    v_mfma_f32_32x32x16_bf16 v[96:111], v[80:83], v[32:35], 0
    buffer_load_dwordx4 v[248:251], v22, s[16:19], s34 offen offset:2048
    v_exp_f32 v112, v112
    v_exp_f32 v113, v113
    v_exp_f32 v114, v114
    v_exp_f32 v115, v115
    v_cvt_pk_bf16_f32 v136, v112, v113
    v_mfma_f32_32x32x16_bf16 v[96:111], v[84:87], v[36:39], v[96:111]
    buffer_load_dwordx4 v[252:255], v22, s[16:19], s34 offen offset:3072
    v_exp_f32 v116, v116
    v_cvt_pk_bf16_f32 v137, v114, v115
    v_exp_f32 v117, v117
    v_exp_f32 v118, v118
    v_exp_f32 v119, v119
    v_cvt_pk_bf16_f32 v138, v116, v117
    v_mfma_f32_32x32x16_bf16 a[32:47], v[72:75], v[128:131], 0
    s_waitcnt lgkmcnt(0)
    v_add_f32 v160, v160, v161
    v_add_f32 v162, v162, v163
    v_and_b32 v160, s90, v160
    v_exp_f32 v120, v120
    v_cvt_pk_bf16_f32 v139, v118, v119
    v_exp_f32 v121, v121
    v_exp_f32 v122, v122
    v_exp_f32 v123, v123
    v_cvt_pk_bf16_f32 v140, v120, v121
    v_mfma_f32_32x32x16_bf16 a[32:47], v[76:79], v[132:135], a[32:47]
    s_branch KA_sk1
KA_t1:
    s_branch KA_tret
KA_sk1:
    v_and_b32 v162, s91, v162
    v_add_f32 v162, v160, v162
    v_cvt_pk_bf16_f32 v160, v162, v162
    v_exp_f32 v124, v124
    v_cvt_pk_bf16_f32 v141, v122, v123
    v_exp_f32 v125, v125
    v_exp_f32 v126, v126
    v_exp_f32 v127, v127
    v_cvt_pk_bf16_f32 v142, v124, v125
    v_cvt_pk_bf16_f32 v143, v126, v127
    v_mfma_f32_32x32x16_bf16 v[112:127], v[80:83], v[40:43], 0
    buffer_store_dwordx4 v[144:147], v1, s[24:27], s88 offen offset:0 sc1
    v_exp_f32 v96, v96
    v_exp_f32 v97, v97
    v_exp_f32 v98, v98
    v_exp_f32 v99, v99
    v_cvt_pk_bf16_f32 v128, v96, v97
    v_mfma_f32_32x32x16_bf16 v[112:127], v[84:87], v[44:47], v[112:127]
    buffer_store_dwordx4 v[148:151], v1, s[24:27], s89 offen offset:0 sc1
    v_exp_f32 v100, v100
    v_cvt_pk_bf16_f32 v129, v98, v99
    v_exp_f32 v101, v101
    v_exp_f32 v102, v102
    v_exp_f32 v103, v103
    v_cvt_pk_bf16_f32 v130, v100, v101
    v_mfma_f32_32x32x16_bf16 v[224:239], v[72:75], v[136:139], 0
    v_lshlrev_b32 v161, 16, v160
    v_sub_f32 v161, v162, v161
    v_cvt_pk_bf16_f32 v161, v161, v165
    buffer_store_dwordx2 v[160:161], v164, s[24:27], s71 offen sc1
    v_exp_f32 v104, v104
    v_cvt_pk_bf16_f32 v131, v102, v103
    v_exp_f32 v105, v105
    v_exp_f32 v106, v106
    v_exp_f32 v107, v107
    v_cvt_pk_bf16_f32 v132, v104, v105
    v_mfma_f32_32x32x16_bf16 v[224:239], v[76:79], v[140:143], v[224:239]
    buffer_load_dwordx4 a[64:67], v23, s[16:19], s34 offen offset:0
    v_exp_f32 v108, v108
    v_cvt_pk_bf16_f32 v133, v106, v107
    v_exp_f32 v109, v109
    v_exp_f32 v110, v110
    v_exp_f32 v111, v111
    v_cvt_pk_bf16_f32 v134, v108, v109
    v_cvt_pk_bf16_f32 v135, v110, v111
    v_mfma_f32_32x32x16_bf16 v[96:111], v[80:83], v[48:51], 0
    buffer_store_dwordx4 v[152:155], v1, s[24:27], s88 offen offset:1024 sc1
    v_exp_f32 v112, v112
    v_exp_f32 v113, v113
    v_exp_f32 v114, v114
    v_exp_f32 v115, v115
    v_cvt_pk_bf16_f32 v136, v112, v113
    v_mfma_f32_32x32x16_bf16 v[96:111], v[84:87], v[52:55], v[96:111]
    v_exp_f32 v116, v116
    v_cvt_pk_bf16_f32 v137, v114, v115
    v_exp_f32 v117, v117
    v_exp_f32 v118, v118
    v_exp_f32 v119, v119
    v_cvt_pk_bf16_f32 v138, v116, v117
    v_mfma_f32_32x32x16_bf16 a[0:15], v[88:91], v[128:131], a[0:15]
    buffer_store_dwordx4 v[156:159], v1, s[24:27], s89 offen offset:1024 sc1
    v_exp_f32 v120, v120
    v_cvt_pk_bf16_f32 v139, v118, v119
    v_exp_f32 v121, v121
    v_exp_f32 v122, v122
    v_exp_f32 v123, v123
    v_cvt_pk_bf16_f32 v140, v120, v121
    v_mfma_f32_32x32x16_bf16 a[0:15], v[92:95], v[132:135], a[0:15]
    buffer_load_dwordx4 a[68:71], v23, s[16:19], s34 offen offset:1024
    v_exp_f32 v124, v124
    v_cvt_pk_bf16_f32 v141, v122, v123
    v_exp_f32 v125, v125
    v_exp_f32 v126, v126
    v_exp_f32 v127, v127
    v_cvt_pk_bf16_f32 v142, v124, v125
    v_cvt_pk_bf16_f32 v143, v126, v127
    v_mfma_f32_32x32x16_bf16 v[112:127], v[80:83], v[56:59], 0
    buffer_load_dwordx4 a[72:75], v23, s[16:19], s34 offen offset:2048
    v_exp_f32 v96, v96
    v_exp_f32 v97, v97
    v_exp_f32 v98, v98
    v_exp_f32 v99, v99
    v_cvt_pk_bf16_f32 v128, v96, v97
    v_mfma_f32_32x32x16_bf16 v[112:127], v[84:87], v[60:63], v[112:127]
    v_exp_f32 v100, v100
    v_cvt_pk_bf16_f32 v129, v98, v99
    v_exp_f32 v101, v101
    v_exp_f32 v102, v102
    v_exp_f32 v103, v103
    v_cvt_pk_bf16_f32 v130, v100, v101
    v_mfma_f32_32x32x16_bf16 a[16:31], v[88:91], v[136:139], a[16:31]
    buffer_load_dwordx4 a[76:79], v23, s[16:19], s34 offen offset:3072
    v_exp_f32 v104, v104
    v_cvt_pk_bf16_f32 v131, v102, v103
    v_exp_f32 v105, v105
    v_exp_f32 v106, v106
    v_exp_f32 v107, v107
    v_cvt_pk_bf16_f32 v132, v104, v105
    v_mfma_f32_32x32x16_bf16 a[16:31], v[92:95], v[140:143], a[16:31]
    s_waitcnt vmcnt(11)
    v_exp_f32 v108, v108
    v_cvt_pk_bf16_f32 v133, v106, v107
    v_exp_f32 v109, v109
    v_exp_f32 v110, v110
    v_exp_f32 v111, v111
    v_cvt_pk_bf16_f32 v134, v108, v109
    v_cvt_pk_bf16_f32 v135, v110, v111
    v_mfma_f32_32x32x16_bf16 v[96:111], v[240:243], v[32:35], 0
    buffer_load_dwordx4 a[80:83], v22, s[16:19], s35 offen offset:0
    v_exp_f32 v112, v112
    v_exp_f32 v113, v113
    v_exp_f32 v114, v114
    v_exp_f32 v115, v115
    v_cvt_pk_bf16_f32 v136, v112, v113
    v_mfma_f32_32x32x16_bf16 v[96:111], v[244:247], v[36:39], v[96:111]
    buffer_load_dwordx4 a[84:87], v22, s[16:19], s35 offen offset:1024
    v_exp_f32 v116, v116
    v_cvt_pk_bf16_f32 v137, v114, v115
    v_exp_f32 v117, v117
    v_exp_f32 v118, v118
    v_exp_f32 v119, v119
    v_cvt_pk_bf16_f32 v138, v116, v117
    v_mfma_f32_32x32x16_bf16 a[32:47], v[88:91], v[128:131], a[32:47]
    v_exp_f32 v120, v120
    v_cvt_pk_bf16_f32 v139, v118, v119
    v_exp_f32 v121, v121
    v_exp_f32 v122, v122
    v_exp_f32 v123, v123
    v_cvt_pk_bf16_f32 v140, v120, v121
    v_mfma_f32_32x32x16_bf16 a[32:47], v[92:95], v[132:135], a[32:47]
    buffer_load_dwordx4 a[88:91], v22, s[16:19], s35 offen offset:2048
    v_exp_f32 v124, v124
    v_cvt_pk_bf16_f32 v141, v122, v123
    v_exp_f32 v125, v125
    v_exp_f32 v126, v126
    v_exp_f32 v127, v127
    v_cvt_pk_bf16_f32 v142, v124, v125
    v_cvt_pk_bf16_f32 v143, v126, v127
    v_mfma_f32_32x32x16_bf16 v[112:127], v[240:243], v[40:43], 0
    buffer_load_dwordx4 a[92:95], v22, s[16:19], s35 offen offset:3072
    v_exp_f32 v96, v96
    v_exp_f32 v97, v97
    v_exp_f32 v98, v98
    v_exp_f32 v99, v99
    v_cvt_pk_bf16_f32 v128, v96, v97
    v_mfma_f32_32x32x16_bf16 v[112:127], v[244:247], v[44:47], v[112:127]
    buffer_load_dwordx4 a[96:99], v23, s[16:19], s35 offen offset:0
    v_exp_f32 v100, v100
    v_cvt_pk_bf16_f32 v129, v98, v99
    v_exp_f32 v101, v101
    v_exp_f32 v102, v102
    v_exp_f32 v103, v103
    v_cvt_pk_bf16_f32 v130, v100, v101
    v_mfma_f32_32x32x16_bf16 v[224:239], v[88:91], v[136:139], v[224:239]
    v_exp_f32 v104, v104
    v_cvt_pk_bf16_f32 v131, v102, v103
    v_exp_f32 v105, v105
    v_exp_f32 v106, v106
    v_exp_f32 v107, v107
    v_cvt_pk_bf16_f32 v132, v104, v105
    v_mfma_f32_32x32x16_bf16 v[224:239], v[92:95], v[140:143], v[224:239]
    buffer_load_dwordx4 a[100:103], v23, s[16:19], s35 offen offset:1024
    v_exp_f32 v108, v108
    v_cvt_pk_bf16_f32 v133, v106, v107
    v_exp_f32 v109, v109
    v_exp_f32 v110, v110
    v_exp_f32 v111, v111
    v_cvt_pk_bf16_f32 v134, v108, v109
    v_cvt_pk_bf16_f32 v135, v110, v111
    v_mfma_f32_32x32x16_bf16 v[96:111], v[240:243], v[48:51], 0
    buffer_load_dwordx4 a[104:107], v23, s[16:19], s35 offen offset:2048
    v_exp_f32 v112, v112
    v_exp_f32 v113, v113
    v_exp_f32 v114, v114
    v_exp_f32 v115, v115
    v_cvt_pk_bf16_f32 v136, v112, v113
    v_mfma_f32_32x32x16_bf16 v[96:111], v[244:247], v[52:55], v[96:111]
    s_waitcnt vmcnt(16)
    v_exp_f32 v116, v116
    v_cvt_pk_bf16_f32 v137, v114, v115
    v_exp_f32 v117, v117
    v_exp_f32 v118, v118
    v_exp_f32 v119, v119
    v_cvt_pk_bf16_f32 v138, v116, v117
    v_mfma_f32_32x32x16_bf16 a[0:15], v[248:251], v[128:131], a[0:15]
    v_exp_f32 v120, v120
    v_cvt_pk_bf16_f32 v139, v118, v119
    v_exp_f32 v121, v121
    v_exp_f32 v122, v122
    v_exp_f32 v123, v123
    v_cvt_pk_bf16_f32 v140, v120, v121
    v_mfma_f32_32x32x16_bf16 a[0:15], v[252:255], v[132:135], a[0:15]
    buffer_load_dwordx4 a[108:111], v23, s[16:19], s35 offen offset:3072
    v_exp_f32 v124, v124
    v_cvt_pk_bf16_f32 v141, v122, v123
    v_exp_f32 v125, v125
    v_exp_f32 v126, v126
    v_exp_f32 v127, v127
    v_cvt_pk_bf16_f32 v142, v124, v125
    v_cvt_pk_bf16_f32 v143, v126, v127
    v_mfma_f32_32x32x16_bf16 v[112:127], v[240:243], v[56:59], 0
    buffer_load_dwordx4 a[112:115], v22, s[16:19], s36 offen offset:0
    v_exp_f32 v96, v96
    v_exp_f32 v97, v97
    v_exp_f32 v98, v98
    v_exp_f32 v99, v99
    v_cvt_pk_bf16_f32 v128, v96, v97
    v_mfma_f32_32x32x16_bf16 v[112:127], v[244:247], v[60:63], v[112:127]
    buffer_load_dwordx4 a[116:119], v22, s[16:19], s36 offen offset:1024
    v_exp_f32 v100, v100
    v_cvt_pk_bf16_f32 v129, v98, v99
    v_exp_f32 v101, v101
    v_exp_f32 v102, v102
    v_exp_f32 v103, v103
    v_cvt_pk_bf16_f32 v130, v100, v101
    v_mfma_f32_32x32x16_bf16 a[16:31], v[248:251], v[136:139], a[16:31]
    v_exp_f32 v104, v104
    v_cvt_pk_bf16_f32 v131, v102, v103
    v_exp_f32 v105, v105
    v_exp_f32 v106, v106
    v_exp_f32 v107, v107
    v_cvt_pk_bf16_f32 v132, v104, v105
    v_mfma_f32_32x32x16_bf16 a[16:31], v[252:255], v[140:143], a[16:31]
    s_waitcnt vmcnt(12)
    v_exp_f32 v108, v108
    v_cvt_pk_bf16_f32 v133, v106, v107
    v_exp_f32 v109, v109
    v_exp_f32 v110, v110
    v_exp_f32 v111, v111
    v_cvt_pk_bf16_f32 v134, v108, v109
    v_cvt_pk_bf16_f32 v135, v110, v111
    v_mfma_f32_32x32x16_bf16 v[96:111], a[64:67], v[32:35], 0
    buffer_load_dwordx4 a[120:123], v22, s[16:19], s36 offen offset:2048
    v_exp_f32 v112, v112
    v_exp_f32 v113, v113
    v_exp_f32 v114, v114
    v_exp_f32 v115, v115
    v_cvt_pk_bf16_f32 v136, v112, v113
    v_mfma_f32_32x32x16_bf16 v[96:111], a[68:71], v[36:39], v[96:111]
    buffer_load_dwordx4 a[124:127], v22, s[16:19], s36 offen offset:3072
    v_exp_f32 v116, v116
    v_cvt_pk_bf16_f32 v137, v114, v115
    v_exp_f32 v117, v117
    v_exp_f32 v118, v118
    v_exp_f32 v119, v119
    v_cvt_pk_bf16_f32 v138, v116, v117
    v_mfma_f32_32x32x16_bf16 a[32:47], v[248:251], v[128:131], a[32:47]
    buffer_load_dwordx4 a[128:131], v23, s[16:19], s36 offen offset:0
    v_exp_f32 v120, v120
    v_cvt_pk_bf16_f32 v139, v118, v119
    v_exp_f32 v121, v121
    v_exp_f32 v122, v122
    v_exp_f32 v123, v123
    v_cvt_pk_bf16_f32 v140, v120, v121
    v_mfma_f32_32x32x16_bf16 a[32:47], v[252:255], v[132:135], a[32:47]
    v_exp_f32 v124, v124
    v_cvt_pk_bf16_f32 v141, v122, v123
    v_exp_f32 v125, v125
    v_exp_f32 v126, v126
    v_exp_f32 v127, v127
    v_cvt_pk_bf16_f32 v142, v124, v125
    v_cvt_pk_bf16_f32 v143, v126, v127
    v_mfma_f32_32x32x16_bf16 v[112:127], a[64:67], v[40:43], 0
    buffer_load_dwordx4 a[132:135], v23, s[16:19], s36 offen offset:1024
    v_exp_f32 v96, v96
    v_exp_f32 v97, v97
    v_exp_f32 v98, v98
    v_exp_f32 v99, v99
    v_cvt_pk_bf16_f32 v128, v96, v97
    v_mfma_f32_32x32x16_bf16 v[112:127], a[68:71], v[44:47], v[112:127]
    buffer_load_dwordx4 a[136:139], v23, s[16:19], s36 offen offset:2048
    v_exp_f32 v100, v100
    v_cvt_pk_bf16_f32 v129, v98, v99
    v_exp_f32 v101, v101
    v_exp_f32 v102, v102
    v_exp_f32 v103, v103
    v_cvt_pk_bf16_f32 v130, v100, v101
    v_mfma_f32_32x32x16_bf16 v[224:239], v[248:251], v[136:139], v[224:239]
    buffer_load_dwordx4 a[140:143], v23, s[16:19], s36 offen offset:3072
    v_exp_f32 v104, v104
    v_cvt_pk_bf16_f32 v131, v102, v103
    v_exp_f32 v105, v105
    v_exp_f32 v106, v106
    v_exp_f32 v107, v107
    v_cvt_pk_bf16_f32 v132, v104, v105
    v_mfma_f32_32x32x16_bf16 v[224:239], v[252:255], v[140:143], v[224:239]
    v_exp_f32 v108, v108
    v_cvt_pk_bf16_f32 v133, v106, v107
    v_exp_f32 v109, v109
    v_exp_f32 v110, v110
    v_exp_f32 v111, v111
    v_cvt_pk_bf16_f32 v134, v108, v109
    v_cvt_pk_bf16_f32 v135, v110, v111
    v_mfma_f32_32x32x16_bf16 v[96:111], a[64:67], v[48:51], 0
    buffer_load_dwordx4 a[144:147], v22, s[16:19], s37 offen offset:0
    v_exp_f32 v112, v112
    v_exp_f32 v113, v113
    v_exp_f32 v114, v114
    v_exp_f32 v115, v115
    v_cvt_pk_bf16_f32 v136, v112, v113
    v_mfma_f32_32x32x16_bf16 v[96:111], a[68:71], v[52:55], v[96:111]
    s_waitcnt vmcnt(17)
    v_exp_f32 v116, v116
    v_cvt_pk_bf16_f32 v137, v114, v115
    v_exp_f32 v117, v117
    v_exp_f32 v118, v118
    v_exp_f32 v119, v119
    v_cvt_pk_bf16_f32 v138, v116, v117
    v_mfma_f32_32x32x16_bf16 a[0:15], a[72:75], v[128:131], a[0:15]
    buffer_load_dwordx4 a[148:151], v22, s[16:19], s37 offen offset:1024
    v_exp_f32 v120, v120
    v_cvt_pk_bf16_f32 v139, v118, v119
    v_exp_f32 v121, v121
    v_exp_f32 v122, v122
    v_exp_f32 v123, v123
    v_cvt_pk_bf16_f32 v140, v120, v121
    v_mfma_f32_32x32x16_bf16 a[0:15], a[76:79], v[132:135], a[0:15]
    v_exp_f32 v124, v124
    v_cvt_pk_bf16_f32 v141, v122, v123
    v_exp_f32 v125, v125
    v_exp_f32 v126, v126
    v_exp_f32 v127, v127
    v_cvt_pk_bf16_f32 v142, v124, v125
    v_cvt_pk_bf16_f32 v143, v126, v127
    v_mfma_f32_32x32x16_bf16 v[112:127], a[64:67], v[56:59], 0
    s_mov_b64 exec, 1
    global_store_byte v16, v17, s[66:67] offset:0 sc0 sc1
    s_mov_b64 exec, -1
    v_exp_f32 v96, v96
    v_exp_f32 v97, v97
    v_exp_f32 v98, v98
    v_exp_f32 v99, v99
    v_cvt_pk_bf16_f32 v128, v96, v97
    v_mfma_f32_32x32x16_bf16 v[112:127], a[68:71], v[60:63], v[112:127]
    buffer_load_dwordx4 a[152:155], v22, s[16:19], s37 offen offset:2048
    v_exp_f32 v100, v100
    v_cvt_pk_bf16_f32 v129, v98, v99
    v_exp_f32 v101, v101
    v_exp_f32 v102, v102
    v_exp_f32 v103, v103
    v_cvt_pk_bf16_f32 v130, v100, v101
    v_mfma_f32_32x32x16_bf16 a[16:31], a[72:75], v[136:139], a[16:31]
    buffer_load_dwordx4 a[156:159], v22, s[16:19], s37 offen offset:3072
    v_exp_f32 v104, v104
    v_cvt_pk_bf16_f32 v131, v102, v103
    v_exp_f32 v105, v105
    v_exp_f32 v106, v106
    v_exp_f32 v107, v107
    v_cvt_pk_bf16_f32 v132, v104, v105
    v_mfma_f32_32x32x16_bf16 a[16:31], a[76:79], v[140:143], a[16:31]
    s_waitcnt vmcnt(19)
    v_exp_f32 v108, v108
    v_cvt_pk_bf16_f32 v133, v106, v107
    v_exp_f32 v109, v109
    v_exp_f32 v110, v110
    v_exp_f32 v111, v111
    v_cvt_pk_bf16_f32 v134, v108, v109
    v_cvt_pk_bf16_f32 v135, v110, v111
    v_mfma_f32_32x32x16_bf16 v[96:111], a[80:83], v[32:35], 0
    buffer_load_dwordx4 a[160:163], v23, s[16:19], s37 offen offset:0
    v_exp_f32 v112, v112
    v_exp_f32 v113, v113
    v_exp_f32 v114, v114
    v_exp_f32 v115, v115
    v_cvt_pk_bf16_f32 v136, v112, v113
    v_mfma_f32_32x32x16_bf16 v[96:111], a[84:87], v[36:39], v[96:111]
    v_exp_f32 v116, v116
    v_cvt_pk_bf16_f32 v137, v114, v115
    v_exp_f32 v117, v117
    v_exp_f32 v118, v118
    v_exp_f32 v119, v119
    v_cvt_pk_bf16_f32 v138, v116, v117
    v_mfma_f32_32x32x16_bf16 a[32:47], a[72:75], v[128:131], a[32:47]
    buffer_load_dwordx4 a[164:167], v23, s[16:19], s37 offen offset:1024
    v_exp_f32 v120, v120
    v_cvt_pk_bf16_f32 v139, v118, v119
    v_exp_f32 v121, v121
    v_exp_f32 v122, v122
    v_exp_f32 v123, v123
    v_cvt_pk_bf16_f32 v140, v120, v121
    v_mfma_f32_32x32x16_bf16 a[32:47], a[76:79], v[132:135], a[32:47]
    buffer_load_dwordx4 a[168:171], v23, s[16:19], s37 offen offset:2048
    v_exp_f32 v124, v124
    v_cvt_pk_bf16_f32 v141, v122, v123
    v_exp_f32 v125, v125
    v_exp_f32 v126, v126
    v_exp_f32 v127, v127
    v_cvt_pk_bf16_f32 v142, v124, v125
    v_cvt_pk_bf16_f32 v143, v126, v127
    v_mfma_f32_32x32x16_bf16 v[112:127], a[80:83], v[40:43], 0
    buffer_load_dwordx4 a[172:175], v23, s[16:19], s37 offen offset:3072
    v_exp_f32 v96, v96
    v_exp_f32 v97, v97
    v_exp_f32 v98, v98
    v_exp_f32 v99, v99
    v_cvt_pk_bf16_f32 v128, v96, v97
    v_mfma_f32_32x32x16_bf16 v[112:127], a[84:87], v[44:47], v[112:127]
    v_exp_f32 v100, v100
    v_cvt_pk_bf16_f32 v129, v98, v99
    v_exp_f32 v101, v101
    v_exp_f32 v102, v102
    v_exp_f32 v103, v103
    v_cvt_pk_bf16_f32 v130, v100, v101
    v_mfma_f32_32x32x16_bf16 v[224:239], a[72:75], v[136:139], v[224:239]
    buffer_load_dwordx4 a[176:179], v22, s[16:19], s38 offen offset:0
    v_exp_f32 v104, v104
    v_cvt_pk_bf16_f32 v131, v102, v103
    v_exp_f32 v105, v105
    v_exp_f32 v106, v106
    v_exp_f32 v107, v107
    v_cvt_pk_bf16_f32 v132, v104, v105
    v_mfma_f32_32x32x16_bf16 v[224:239], a[76:79], v[140:143], v[224:239]
    buffer_load_dwordx4 a[180:183], v22, s[16:19], s38 offen offset:1024
    v_exp_f32 v108, v108
    v_cvt_pk_bf16_f32 v133, v106, v107
    v_exp_f32 v109, v109
    v_exp_f32 v110, v110
    v_exp_f32 v111, v111
    v_cvt_pk_bf16_f32 v134, v108, v109
    v_cvt_pk_bf16_f32 v135, v110, v111
    v_mfma_f32_32x32x16_bf16 v[96:111], a[80:83], v[48:51], 0
    buffer_load_dwordx4 a[184:187], v22, s[16:19], s38 offen offset:2048
    v_exp_f32 v112, v112
    v_exp_f32 v113, v113
    v_exp_f32 v114, v114
    v_exp_f32 v115, v115
    v_cvt_pk_bf16_f32 v136, v112, v113
    v_mfma_f32_32x32x16_bf16 v[96:111], a[84:87], v[52:55], v[96:111]
    s_waitcnt vmcnt(24)
    v_exp_f32 v116, v116
    v_cvt_pk_bf16_f32 v137, v114, v115
    v_exp_f32 v117, v117
    v_exp_f32 v118, v118
    v_exp_f32 v119, v119
    v_cvt_pk_bf16_f32 v138, v116, v117
    v_mfma_f32_32x32x16_bf16 a[0:15], a[88:91], v[128:131], a[0:15]
    v_exp_f32 v120, v120
    v_cvt_pk_bf16_f32 v139, v118, v119
    v_exp_f32 v121, v121
    v_exp_f32 v122, v122
    v_exp_f32 v123, v123
    v_cvt_pk_bf16_f32 v140, v120, v121
    v_mfma_f32_32x32x16_bf16 a[0:15], a[92:95], v[132:135], a[0:15]
    buffer_load_dwordx4 a[188:191], v22, s[16:19], s38 offen offset:3072
    v_exp_f32 v124, v124
    v_cvt_pk_bf16_f32 v141, v122, v123
    v_exp_f32 v125, v125
    v_exp_f32 v126, v126
    v_exp_f32 v127, v127
    v_cvt_pk_bf16_f32 v142, v124, v125
    v_cvt_pk_bf16_f32 v143, v126, v127
    v_mfma_f32_32x32x16_bf16 v[112:127], a[80:83], v[56:59], 0
    buffer_load_dwordx4 a[192:195], v23, s[16:19], s38 offen offset:0
    v_exp_f32 v96, v96
    v_exp_f32 v97, v97
    v_exp_f32 v98, v98
    v_exp_f32 v99, v99
    v_cvt_pk_bf16_f32 v128, v96, v97
    v_mfma_f32_32x32x16_bf16 v[112:127], a[84:87], v[60:63], v[112:127]
    v_exp_f32 v100, v100
    v_cvt_pk_bf16_f32 v129, v98, v99
    v_exp_f32 v101, v101
    v_exp_f32 v102, v102
    v_exp_f32 v103, v103
    v_cvt_pk_bf16_f32 v130, v100, v101
    v_mfma_f32_32x32x16_bf16 a[16:31], a[88:91], v[136:139], a[16:31]
    buffer_load_dwordx4 a[196:199], v23, s[16:19], s38 offen offset:1024
    v_exp_f32 v104, v104
    v_cvt_pk_bf16_f32 v131, v102, v103
    v_exp_f32 v105, v105
    v_exp_f32 v106, v106
    v_exp_f32 v107, v107
    v_cvt_pk_bf16_f32 v132, v104, v105
    v_mfma_f32_32x32x16_bf16 a[16:31], a[92:95], v[140:143], a[16:31]
    s_waitcnt vmcnt(25)
    v_exp_f32 v108, v108
    v_cvt_pk_bf16_f32 v133, v106, v107
    v_exp_f32 v109, v109
    v_exp_f32 v110, v110
    v_exp_f32 v111, v111
    v_cvt_pk_bf16_f32 v134, v108, v109
    v_cvt_pk_bf16_f32 v135, v110, v111
    v_mfma_f32_32x32x16_bf16 v[96:111], a[96:99], v[32:35], 0
    buffer_load_dwordx4 a[200:203], v23, s[16:19], s38 offen offset:2048
    v_exp_f32 v112, v112
    v_exp_f32 v113, v113
    v_exp_f32 v114, v114
    v_exp_f32 v115, v115
    v_cvt_pk_bf16_f32 v136, v112, v113
    v_mfma_f32_32x32x16_bf16 v[96:111], a[100:103], v[36:39], v[96:111]
    buffer_load_dwordx4 a[204:207], v23, s[16:19], s38 offen offset:3072
    v_exp_f32 v116, v116
    v_cvt_pk_bf16_f32 v137, v114, v115
    v_exp_f32 v117, v117
    v_exp_f32 v118, v118
    v_exp_f32 v119, v119
    v_cvt_pk_bf16_f32 v138, v116, v117
    v_mfma_f32_32x32x16_bf16 a[32:47], a[88:91], v[128:131], a[32:47]
    v_exp_f32 v120, v120
    v_cvt_pk_bf16_f32 v139, v118, v119
    v_exp_f32 v121, v121
    v_exp_f32 v122, v122
    v_exp_f32 v123, v123
    v_cvt_pk_bf16_f32 v140, v120, v121
    v_mfma_f32_32x32x16_bf16 a[32:47], a[92:95], v[132:135], a[32:47]
    buffer_load_dwordx4 a[208:211], v22, s[16:19], s39 offen offset:0
    v_exp_f32 v124, v124
    v_cvt_pk_bf16_f32 v141, v122, v123
    v_exp_f32 v125, v125
    v_exp_f32 v126, v126
    v_exp_f32 v127, v127
    v_cvt_pk_bf16_f32 v142, v124, v125
    v_cvt_pk_bf16_f32 v143, v126, v127
    v_mfma_f32_32x32x16_bf16 v[112:127], a[96:99], v[40:43], 0
    buffer_load_dwordx4 a[212:215], v22, s[16:19], s39 offen offset:1024
    v_exp_f32 v96, v96
    v_exp_f32 v97, v97
    v_exp_f32 v98, v98
    v_exp_f32 v99, v99
    v_cvt_pk_bf16_f32 v128, v96, v97
    v_mfma_f32_32x32x16_bf16 v[112:127], a[100:103], v[44:47], v[112:127]
    buffer_load_dwordx4 a[216:219], v22, s[16:19], s39 offen offset:2048
    v_exp_f32 v100, v100
    v_cvt_pk_bf16_f32 v129, v98, v99
    v_exp_f32 v101, v101
    v_exp_f32 v102, v102
    v_exp_f32 v103, v103
    v_cvt_pk_bf16_f32 v130, v100, v101
    v_mfma_f32_32x32x16_bf16 v[224:239], a[88:91], v[136:139], v[224:239]
    v_exp_f32 v104, v104
    v_cvt_pk_bf16_f32 v131, v102, v103
    v_exp_f32 v105, v105
    v_exp_f32 v106, v106
    v_exp_f32 v107, v107
    v_cvt_pk_bf16_f32 v132, v104, v105
    v_mfma_f32_32x32x16_bf16 v[224:239], a[92:95], v[140:143], v[224:239]
    buffer_load_dwordx4 a[220:223], v22, s[16:19], s39 offen offset:3072
    v_exp_f32 v108, v108
    v_cvt_pk_bf16_f32 v133, v106, v107
    v_exp_f32 v109, v109
    v_exp_f32 v110, v110
    v_exp_f32 v111, v111
    v_cvt_pk_bf16_f32 v134, v108, v109
    v_cvt_pk_bf16_f32 v135, v110, v111
    v_mfma_f32_32x32x16_bf16 v[96:111], a[96:99], v[48:51], 0
    buffer_load_dwordx4 v[64:67], v23, s[16:19], s39 offen offset:0
    v_exp_f32 v112, v112
    v_exp_f32 v113, v113
    v_exp_f32 v114, v114
    v_exp_f32 v115, v115
    v_cvt_pk_bf16_f32 v136, v112, v113
    v_mfma_f32_32x32x16_bf16 v[96:111], a[100:103], v[52:55], v[96:111]
    s_waitcnt vmcnt(30)
    v_exp_f32 v116, v116
    v_cvt_pk_bf16_f32 v137, v114, v115
    v_exp_f32 v117, v117
    v_exp_f32 v118, v118
    v_exp_f32 v119, v119
    v_cvt_pk_bf16_f32 v138, v116, v117
    v_mfma_f32_32x32x16_bf16 a[0:15], a[104:107], v[128:131], a[0:15]
    buffer_load_dwordx4 v[68:71], v23, s[16:19], s39 offen offset:1024
    v_exp_f32 v120, v120
    v_cvt_pk_bf16_f32 v139, v118, v119
    v_exp_f32 v121, v121
    v_exp_f32 v122, v122
    v_exp_f32 v123, v123
    v_cvt_pk_bf16_f32 v140, v120, v121
    v_mfma_f32_32x32x16_bf16 a[0:15], a[108:111], v[132:135], a[0:15]
    v_exp_f32 v124, v124
    v_cvt_pk_bf16_f32 v141, v122, v123
    v_exp_f32 v125, v125
    v_exp_f32 v126, v126
    v_exp_f32 v127, v127
    v_cvt_pk_bf16_f32 v142, v124, v125
    v_cvt_pk_bf16_f32 v143, v126, v127
    v_mfma_f32_32x32x16_bf16 v[112:127], a[96:99], v[56:59], 0
    buffer_load_dwordx4 v[72:75], v23, s[16:19], s39 offen offset:2048
    v_exp_f32 v96, v96
    v_exp_f32 v97, v97
    v_exp_f32 v98, v98
    v_exp_f32 v99, v99
    v_cvt_pk_bf16_f32 v128, v96, v97
    v_mfma_f32_32x32x16_bf16 v[112:127], a[100:103], v[60:63], v[112:127]
    buffer_load_dwordx4 v[76:79], v23, s[16:19], s39 offen offset:3072
    v_exp_f32 v100, v100
    v_cvt_pk_bf16_f32 v129, v98, v99
    v_exp_f32 v101, v101
    v_exp_f32 v102, v102
    v_exp_f32 v103, v103
    v_cvt_pk_bf16_f32 v130, v100, v101
    v_mfma_f32_32x32x16_bf16 a[16:31], a[104:107], v[136:139], a[16:31]
    v_exp_f32 v104, v104
    v_cvt_pk_bf16_f32 v131, v102, v103
    v_exp_f32 v105, v105
    v_exp_f32 v106, v106
    v_exp_f32 v107, v107
    v_cvt_pk_bf16_f32 v132, v104, v105
    v_mfma_f32_32x32x16_bf16 a[16:31], a[108:111], v[140:143], a[16:31]
    s_waitcnt vmcnt(31)
    v_exp_f32 v108, v108
    v_cvt_pk_bf16_f32 v133, v106, v107
    v_exp_f32 v109, v109
    v_exp_f32 v110, v110
    v_exp_f32 v111, v111
    v_cvt_pk_bf16_f32 v134, v108, v109
    v_cvt_pk_bf16_f32 v135, v110, v111
    v_mfma_f32_32x32x16_bf16 v[96:111], a[112:115], v[32:35], 0
    buffer_load_dwordx4 v[80:83], v22, s[16:19], s40 offen offset:0
    v_exp_f32 v112, v112
    v_exp_f32 v113, v113
    v_exp_f32 v114, v114
    v_exp_f32 v115, v115
    v_cvt_pk_bf16_f32 v136, v112, v113
    v_mfma_f32_32x32x16_bf16 v[96:111], a[116:119], v[36:39], v[96:111]
    buffer_load_dwordx4 v[84:87], v22, s[16:19], s40 offen offset:1024
    v_exp_f32 v116, v116
    v_cvt_pk_bf16_f32 v137, v114, v115
    v_exp_f32 v117, v117
    v_exp_f32 v118, v118
    v_exp_f32 v119, v119
    v_cvt_pk_bf16_f32 v138, v116, v117
    v_mfma_f32_32x32x16_bf16 a[32:47], a[104:107], v[128:131], a[32:47]
    buffer_load_dwordx4 v[88:91], v22, s[16:19], s40 offen offset:2048
    v_exp_f32 v120, v120
    v_cvt_pk_bf16_f32 v139, v118, v119
    v_exp_f32 v121, v121
    v_exp_f32 v122, v122
    v_exp_f32 v123, v123
    v_cvt_pk_bf16_f32 v140, v120, v121
    v_mfma_f32_32x32x16_bf16 a[32:47], a[108:111], v[132:135], a[32:47]
    v_exp_f32 v124, v124
    v_cvt_pk_bf16_f32 v141, v122, v123
    v_exp_f32 v125, v125
    v_exp_f32 v126, v126
    v_exp_f32 v127, v127
    v_cvt_pk_bf16_f32 v142, v124, v125
    v_cvt_pk_bf16_f32 v143, v126, v127
    v_mfma_f32_32x32x16_bf16 v[112:127], a[112:115], v[40:43], 0
    buffer_load_dwordx4 v[92:95], v22, s[16:19], s40 offen offset:3072
    v_exp_f32 v96, v96
    v_exp_f32 v97, v97
    v_exp_f32 v98, v98
    v_exp_f32 v99, v99
    v_cvt_pk_bf16_f32 v128, v96, v97
    v_mfma_f32_32x32x16_bf16 v[112:127], a[116:119], v[44:47], v[112:127]
    buffer_load_dwordx4 v[240:243], v23, s[16:19], s40 offen offset:0
    v_exp_f32 v100, v100
    v_cvt_pk_bf16_f32 v129, v98, v99
    v_exp_f32 v101, v101
    v_exp_f32 v102, v102
    v_exp_f32 v103, v103
    v_cvt_pk_bf16_f32 v130, v100, v101
    v_mfma_f32_32x32x16_bf16 v[224:239], a[104:107], v[136:139], v[224:239]
    buffer_load_dwordx4 v[244:247], v23, s[16:19], s40 offen offset:1024
    v_exp_f32 v104, v104
    v_cvt_pk_bf16_f32 v131, v102, v103
    v_exp_f32 v105, v105
    v_exp_f32 v106, v106
    v_exp_f32 v107, v107
    v_cvt_pk_bf16_f32 v132, v104, v105
    v_mfma_f32_32x32x16_bf16 v[224:239], a[108:111], v[140:143], v[224:239]
    v_exp_f32 v108, v108
    v_cvt_pk_bf16_f32 v133, v106, v107
    v_exp_f32 v109, v109
    v_exp_f32 v110, v110
    v_exp_f32 v111, v111
    v_cvt_pk_bf16_f32 v134, v108, v109
    v_cvt_pk_bf16_f32 v135, v110, v111
    v_mfma_f32_32x32x16_bf16 v[96:111], a[112:115], v[48:51], 0
    buffer_load_dwordx4 v[248:251], v23, s[16:19], s40 offen offset:2048
    v_exp_f32 v112, v112
    v_exp_f32 v113, v113
    v_exp_f32 v114, v114
    v_exp_f32 v115, v115
    v_cvt_pk_bf16_f32 v136, v112, v113
    v_mfma_f32_32x32x16_bf16 v[96:111], a[116:119], v[52:55], v[96:111]
    s_waitcnt vmcnt(36)
    v_exp_f32 v116, v116
    v_cvt_pk_bf16_f32 v137, v114, v115
    v_exp_f32 v117, v117
    v_exp_f32 v118, v118
    v_exp_f32 v119, v119
    v_cvt_pk_bf16_f32 v138, v116, v117
    v_mfma_f32_32x32x16_bf16 a[0:15], a[120:123], v[128:131], a[0:15]
    buffer_load_dwordx4 v[252:255], v23, s[16:19], s40 offen offset:3072
    v_exp_f32 v120, v120
    v_cvt_pk_bf16_f32 v139, v118, v119
    v_exp_f32 v121, v121
    v_exp_f32 v122, v122
    v_exp_f32 v123, v123
    v_cvt_pk_bf16_f32 v140, v120, v121
    v_mfma_f32_32x32x16_bf16 a[0:15], a[124:127], v[132:135], a[0:15]
    global_load_dwordx4 v[16:19], v20, s[8:9] sc1
    v_exp_f32 v124, v124
    v_cvt_pk_bf16_f32 v141, v122, v123
    v_exp_f32 v125, v125
    v_exp_f32 v126, v126
    v_exp_f32 v127, v127
    v_cvt_pk_bf16_f32 v142, v124, v125
    v_cvt_pk_bf16_f32 v143, v126, v127
    v_mfma_f32_32x32x16_bf16 v[112:127], a[112:115], v[56:59], 0
    s_branch KA_sk2
KA_t2:
    s_branch KA_tret
KA_sk2:
    v_exp_f32 v96, v96
    v_exp_f32 v97, v97
    v_exp_f32 v98, v98
    v_exp_f32 v99, v99
    v_cvt_pk_bf16_f32 v128, v96, v97
    v_mfma_f32_32x32x16_bf16 v[112:127], a[116:119], v[60:63], v[112:127]
    v_exp_f32 v100, v100
    v_cvt_pk_bf16_f32 v129, v98, v99
    v_exp_f32 v101, v101
    v_exp_f32 v102, v102
    v_exp_f32 v103, v103
    v_cvt_pk_bf16_f32 v130, v100, v101
    v_mfma_f32_32x32x16_bf16 a[16:31], a[120:123], v[136:139], a[16:31]
    v_exp_f32 v104, v104
    v_cvt_pk_bf16_f32 v131, v102, v103
    v_exp_f32 v105, v105
    v_exp_f32 v106, v106
    v_exp_f32 v107, v107
    v_cvt_pk_bf16_f32 v132, v104, v105
    v_mfma_f32_32x32x16_bf16 a[16:31], a[124:127], v[140:143], a[16:31]
    s_waitcnt vmcnt(36)
    v_exp_f32 v108, v108
    v_cvt_pk_bf16_f32 v133, v106, v107
    v_exp_f32 v109, v109
    v_exp_f32 v110, v110
    v_exp_f32 v111, v111
    v_cvt_pk_bf16_f32 v134, v108, v109
    v_cvt_pk_bf16_f32 v135, v110, v111
    v_mfma_f32_32x32x16_bf16 v[96:111], a[128:131], v[32:35], 0
    v_exp_f32 v112, v112
    v_exp_f32 v113, v113
    v_exp_f32 v114, v114
    v_exp_f32 v115, v115
    v_cvt_pk_bf16_f32 v136, v112, v113
    v_mfma_f32_32x32x16_bf16 v[96:111], a[132:135], v[36:39], v[96:111]
    v_exp_f32 v116, v116
    v_cvt_pk_bf16_f32 v137, v114, v115
    v_exp_f32 v117, v117
    v_exp_f32 v118, v118
    v_exp_f32 v119, v119
    v_cvt_pk_bf16_f32 v138, v116, v117
    v_mfma_f32_32x32x16_bf16 a[32:47], a[120:123], v[128:131], a[32:47]
    v_exp_f32 v120, v120
    v_cvt_pk_bf16_f32 v139, v118, v119
    v_exp_f32 v121, v121
    v_exp_f32 v122, v122
    v_exp_f32 v123, v123
    v_cvt_pk_bf16_f32 v140, v120, v121
    v_mfma_f32_32x32x16_bf16 a[32:47], a[124:127], v[132:135], a[32:47]
    v_exp_f32 v124, v124
    v_cvt_pk_bf16_f32 v141, v122, v123
    v_exp_f32 v125, v125
    v_exp_f32 v126, v126
    v_exp_f32 v127, v127
    v_cvt_pk_bf16_f32 v142, v124, v125
    v_cvt_pk_bf16_f32 v143, v126, v127
    v_mfma_f32_32x32x16_bf16 v[112:127], a[128:131], v[40:43], 0
    s_waitcnt vmcnt(0)
    v_and_b32 v16, v16, v17
    v_and_b32 v18, v18, v19
    v_and_b32 v16, v16, v18
    v_and_b32 v16, 0x10101010, v16
    v_cmp_ne_u32 vcc, 0x10101010, v16
    s_cbranch_vccnz KB_wspin
KB_wspin_done:
    v_exp_f32 v96, v96
    v_exp_f32 v97, v97
    v_exp_f32 v98, v98
    v_exp_f32 v99, v99
    v_cvt_pk_bf16_f32 v128, v96, v97
    v_mfma_f32_32x32x16_bf16 v[112:127], a[132:135], v[44:47], v[112:127]
    v_exp_f32 v100, v100
    v_cvt_pk_bf16_f32 v129, v98, v99
    v_exp_f32 v101, v101
    v_exp_f32 v102, v102
    v_exp_f32 v103, v103
    v_cvt_pk_bf16_f32 v130, v100, v101
    v_mfma_f32_32x32x16_bf16 v[224:239], a[120:123], v[136:139], v[224:239]
    v_exp_f32 v104, v104
    v_cvt_pk_bf16_f32 v131, v102, v103
    v_exp_f32 v105, v105
    v_exp_f32 v106, v106
    v_exp_f32 v107, v107
    v_cvt_pk_bf16_f32 v132, v104, v105
    v_mfma_f32_32x32x16_bf16 v[224:239], a[124:127], v[140:143], v[224:239]
    v_exp_f32 v108, v108
    v_cvt_pk_bf16_f32 v133, v106, v107
    v_exp_f32 v109, v109
    v_exp_f32 v110, v110
    v_exp_f32 v111, v111
    v_cvt_pk_bf16_f32 v134, v108, v109
    v_cvt_pk_bf16_f32 v135, v110, v111
    v_mfma_f32_32x32x16_bf16 v[96:111], a[128:131], v[48:51], 0
    v_exp_f32 v112, v112
    v_exp_f32 v113, v113
    v_exp_f32 v114, v114
    v_exp_f32 v115, v115
    v_cvt_pk_bf16_f32 v136, v112, v113
    v_mfma_f32_32x32x16_bf16 v[96:111], a[132:135], v[52:55], v[96:111]
    v_exp_f32 v116, v116
    v_cvt_pk_bf16_f32 v137, v114, v115
    v_exp_f32 v117, v117
    v_exp_f32 v118, v118
    v_exp_f32 v119, v119
    v_cvt_pk_bf16_f32 v138, v116, v117
    v_mfma_f32_32x32x16_bf16 a[0:15], a[136:139], v[128:131], a[0:15]
    global_load_dword v31, v21, s[8:9]
    v_exp_f32 v120, v120
    v_cvt_pk_bf16_f32 v139, v118, v119
    v_exp_f32 v121, v121
    v_exp_f32 v122, v122
    v_exp_f32 v123, v123
    v_cvt_pk_bf16_f32 v140, v120, v121
    v_mfma_f32_32x32x16_bf16 a[0:15], a[140:143], v[132:135], a[0:15]
    v_exp_f32 v124, v124
    v_cvt_pk_bf16_f32 v141, v122, v123
    v_exp_f32 v125, v125
    v_exp_f32 v126, v126
    v_exp_f32 v127, v127
    v_cvt_pk_bf16_f32 v142, v124, v125
    v_cvt_pk_bf16_f32 v143, v126, v127
    v_mfma_f32_32x32x16_bf16 v[112:127], a[128:131], v[56:59], 0
    global_load_dwordx4 v[144:147], v1, s[48:49] offset:-4096
    v_exp_f32 v96, v96
    v_exp_f32 v97, v97
    v_exp_f32 v98, v98
    v_exp_f32 v99, v99
    v_cvt_pk_bf16_f32 v128, v96, v97
    v_mfma_f32_32x32x16_bf16 v[112:127], a[132:135], v[60:63], v[112:127]
    global_load_dwordx4 v[148:151], v1, s[48:49] offset:-3072
    v_exp_f32 v100, v100
    v_cvt_pk_bf16_f32 v129, v98, v99
    v_exp_f32 v101, v101
    v_exp_f32 v102, v102
    v_exp_f32 v103, v103
    v_cvt_pk_bf16_f32 v130, v100, v101
    v_mfma_f32_32x32x16_bf16 a[16:31], a[136:139], v[136:139], a[16:31]
    v_exp_f32 v104, v104
    v_cvt_pk_bf16_f32 v131, v102, v103
    v_exp_f32 v105, v105
    v_exp_f32 v106, v106
    v_exp_f32 v107, v107
    v_cvt_pk_bf16_f32 v132, v104, v105
    v_mfma_f32_32x32x16_bf16 a[16:31], a[140:143], v[140:143], a[16:31]
    global_load_dwordx4 v[152:155], v1, s[48:49] offset:-2048
    v_exp_f32 v108, v108
    v_cvt_pk_bf16_f32 v133, v106, v107
    v_exp_f32 v109, v109
    v_exp_f32 v110, v110
    v_exp_f32 v111, v111
    v_cvt_pk_bf16_f32 v134, v108, v109
    v_cvt_pk_bf16_f32 v135, v110, v111
    v_mfma_f32_32x32x16_bf16 v[96:111], a[144:147], v[32:35], 0
    global_load_dwordx4 v[156:159], v1, s[48:49] offset:-1024
    v_exp_f32 v112, v112
    v_exp_f32 v113, v113
    v_exp_f32 v114, v114
    v_exp_f32 v115, v115
    v_cvt_pk_bf16_f32 v136, v112, v113
    v_mfma_f32_32x32x16_bf16 v[96:111], a[148:151], v[36:39], v[96:111]
    v_exp_f32 v116, v116
    v_cvt_pk_bf16_f32 v137, v114, v115
    v_exp_f32 v117, v117
    v_exp_f32 v118, v118
    v_exp_f32 v119, v119
    v_cvt_pk_bf16_f32 v138, v116, v117
    v_mfma_f32_32x32x16_bf16 a[32:47], a[136:139], v[128:131], a[32:47]
    global_load_dwordx4 v[160:163], v1, s[48:49] offset:0
    v_exp_f32 v120, v120
    v_cvt_pk_bf16_f32 v139, v118, v119
    v_exp_f32 v121, v121
    v_exp_f32 v122, v122
    v_exp_f32 v123, v123
    v_cvt_pk_bf16_f32 v140, v120, v121
    v_mfma_f32_32x32x16_bf16 a[32:47], a[140:143], v[132:135], a[32:47]
    v_exp_f32 v124, v124
    v_cvt_pk_bf16_f32 v141, v122, v123
    v_exp_f32 v125, v125
    v_exp_f32 v126, v126
    v_exp_f32 v127, v127
    v_cvt_pk_bf16_f32 v142, v124, v125
    v_cvt_pk_bf16_f32 v143, v126, v127
    v_mfma_f32_32x32x16_bf16 v[112:127], a[144:147], v[40:43], 0
    global_load_dwordx4 v[164:167], v1, s[48:49] offset:1024
    v_exp_f32 v96, v96
    v_exp_f32 v97, v97
    v_exp_f32 v98, v98
    v_exp_f32 v99, v99
    v_cvt_pk_bf16_f32 v128, v96, v97
    v_mfma_f32_32x32x16_bf16 v[112:127], a[148:151], v[44:47], v[112:127]
    global_load_dwordx4 v[168:171], v1, s[48:49] offset:2048
    v_exp_f32 v100, v100
    v_cvt_pk_bf16_f32 v129, v98, v99
    v_exp_f32 v101, v101
    v_exp_f32 v102, v102
    v_exp_f32 v103, v103
    v_cvt_pk_bf16_f32 v130, v100, v101
    v_mfma_f32_32x32x16_bf16 v[224:239], a[136:139], v[136:139], v[224:239]
    global_load_dword v4, v10, s[56:57] offset:-4096
    v_exp_f32 v104, v104
    v_cvt_pk_bf16_f32 v131, v102, v103
    v_exp_f32 v105, v105
    v_exp_f32 v106, v106
    v_exp_f32 v107, v107
    v_cvt_pk_bf16_f32 v132, v104, v105
    v_mfma_f32_32x32x16_bf16 v[224:239], a[140:143], v[140:143], v[224:239]
    v_exp_f32 v108, v108
    v_cvt_pk_bf16_f32 v133, v106, v107
    v_exp_f32 v109, v109
    v_exp_f32 v110, v110
    v_exp_f32 v111, v111
    v_cvt_pk_bf16_f32 v134, v108, v109
    v_cvt_pk_bf16_f32 v135, v110, v111
    v_mfma_f32_32x32x16_bf16 v[96:111], a[144:147], v[48:51], 0
    global_load_dwordx4 v[172:175], v1, s[48:49] offset:3072
    v_exp_f32 v112, v112
    v_exp_f32 v113, v113
    v_exp_f32 v114, v114
    v_exp_f32 v115, v115
    v_cvt_pk_bf16_f32 v136, v112, v113
    v_mfma_f32_32x32x16_bf16 v[96:111], a[148:151], v[52:55], v[96:111]
    global_load_dwordx4 v[176:179], v7, s[48:49] offset:-4096
    v_exp_f32 v116, v116
    v_cvt_pk_bf16_f32 v137, v114, v115
    v_exp_f32 v117, v117
    v_exp_f32 v118, v118
    v_exp_f32 v119, v119
    v_cvt_pk_bf16_f32 v138, v116, v117
    v_mfma_f32_32x32x16_bf16 a[0:15], a[152:155], v[128:131], a[0:15]
    v_exp_f32 v120, v120
    v_cvt_pk_bf16_f32 v139, v118, v119
    v_exp_f32 v121, v121
    v_exp_f32 v122, v122
    v_exp_f32 v123, v123
    v_cvt_pk_bf16_f32 v140, v120, v121
    v_mfma_f32_32x32x16_bf16 a[0:15], a[156:159], v[132:135], a[0:15]
    global_load_dwordx4 v[180:183], v7, s[48:49] offset:-3072
    v_exp_f32 v124, v124
    v_cvt_pk_bf16_f32 v141, v122, v123
    v_exp_f32 v125, v125
    v_exp_f32 v126, v126
    v_exp_f32 v127, v127
    v_cvt_pk_bf16_f32 v142, v124, v125
    v_cvt_pk_bf16_f32 v143, v126, v127
    v_mfma_f32_32x32x16_bf16 v[112:127], a[144:147], v[56:59], 0
    v_exp_f32 v96, v96
    v_exp_f32 v97, v97
    v_exp_f32 v98, v98
    v_exp_f32 v99, v99
    v_cvt_pk_bf16_f32 v128, v96, v97
    v_mfma_f32_32x32x16_bf16 v[112:127], a[148:151], v[60:63], v[112:127]
    global_load_dwordx4 v[184:187], v7, s[48:49] offset:-2048
    v_exp_f32 v100, v100
    v_cvt_pk_bf16_f32 v129, v98, v99
    v_exp_f32 v101, v101
    v_exp_f32 v102, v102
    v_exp_f32 v103, v103
    v_cvt_pk_bf16_f32 v130, v100, v101
    v_mfma_f32_32x32x16_bf16 a[16:31], a[152:155], v[136:139], a[16:31]
    global_load_dwordx4 v[188:191], v7, s[48:49] offset:-1024
    v_exp_f32 v104, v104
    v_cvt_pk_bf16_f32 v131, v102, v103
    v_exp_f32 v105, v105
    v_exp_f32 v106, v106
    v_exp_f32 v107, v107
    v_cvt_pk_bf16_f32 v132, v104, v105
    v_mfma_f32_32x32x16_bf16 a[16:31], a[156:159], v[140:143], a[16:31]
    v_exp_f32 v108, v108
    v_cvt_pk_bf16_f32 v133, v106, v107
    v_exp_f32 v109, v109
    v_exp_f32 v110, v110
    v_exp_f32 v111, v111
    v_cvt_pk_bf16_f32 v134, v108, v109
    v_cvt_pk_bf16_f32 v135, v110, v111
    v_mfma_f32_32x32x16_bf16 v[96:111], a[160:163], v[32:35], 0
    global_load_dwordx4 v[192:195], v7, s[48:49] offset:0
    v_exp_f32 v112, v112
    v_exp_f32 v113, v113
    v_exp_f32 v114, v114
    v_exp_f32 v115, v115
    v_cvt_pk_bf16_f32 v136, v112, v113
    v_mfma_f32_32x32x16_bf16 v[96:111], a[164:167], v[36:39], v[96:111]
    global_load_dwordx4 v[196:199], v7, s[48:49] offset:1024
    v_exp_f32 v116, v116
    v_cvt_pk_bf16_f32 v137, v114, v115
    v_exp_f32 v117, v117
    v_exp_f32 v118, v118
    v_exp_f32 v119, v119
    v_cvt_pk_bf16_f32 v138, v116, v117
    v_mfma_f32_32x32x16_bf16 a[32:47], a[152:155], v[128:131], a[32:47]
    global_load_dword v4, v10, s[56:57] offset:-2048
    v_exp_f32 v120, v120
    v_cvt_pk_bf16_f32 v139, v118, v119
    v_exp_f32 v121, v121
    v_exp_f32 v122, v122
    v_exp_f32 v123, v123
    v_cvt_pk_bf16_f32 v140, v120, v121
    v_mfma_f32_32x32x16_bf16 a[32:47], a[156:159], v[132:135], a[32:47]
    v_exp_f32 v124, v124
    v_cvt_pk_bf16_f32 v141, v122, v123
    v_exp_f32 v125, v125
    v_exp_f32 v126, v126
    v_exp_f32 v127, v127
    v_cvt_pk_bf16_f32 v142, v124, v125
    v_cvt_pk_bf16_f32 v143, v126, v127
    v_mfma_f32_32x32x16_bf16 v[112:127], a[160:163], v[40:43], 0
    global_load_dwordx4 v[200:203], v7, s[48:49] offset:2048
    v_exp_f32 v96, v96
    v_exp_f32 v97, v97
    v_exp_f32 v98, v98
    v_exp_f32 v99, v99
    v_cvt_pk_bf16_f32 v128, v96, v97
    v_mfma_f32_32x32x16_bf16 v[112:127], a[164:167], v[44:47], v[112:127]
    v_exp_f32 v100, v100
    v_cvt_pk_bf16_f32 v129, v98, v99
    v_exp_f32 v101, v101
    v_exp_f32 v102, v102
    v_exp_f32 v103, v103
    v_cvt_pk_bf16_f32 v130, v100, v101
    v_mfma_f32_32x32x16_bf16 v[224:239], a[152:155], v[136:139], v[224:239]
    global_load_dwordx4 v[204:207], v7, s[48:49] offset:3072
    v_exp_f32 v104, v104
    v_cvt_pk_bf16_f32 v131, v102, v103
    v_exp_f32 v105, v105
    v_exp_f32 v106, v106
    v_exp_f32 v107, v107
    v_cvt_pk_bf16_f32 v132, v104, v105
    v_mfma_f32_32x32x16_bf16 v[224:239], a[156:159], v[140:143], v[224:239]
    global_load_dwordx4 v[208:211], v1, s[50:51] offset:-4096
    v_exp_f32 v108, v108
    v_cvt_pk_bf16_f32 v133, v106, v107
    v_exp_f32 v109, v109
    v_exp_f32 v110, v110
    v_exp_f32 v111, v111
    v_cvt_pk_bf16_f32 v134, v108, v109
    v_cvt_pk_bf16_f32 v135, v110, v111
    v_mfma_f32_32x32x16_bf16 v[96:111], a[160:163], v[48:51], 0
    v_exp_f32 v112, v112
    v_exp_f32 v113, v113
    v_exp_f32 v114, v114
    v_exp_f32 v115, v115
    v_cvt_pk_bf16_f32 v136, v112, v113
    v_mfma_f32_32x32x16_bf16 v[96:111], a[164:167], v[52:55], v[96:111]
    global_load_dwordx4 v[212:215], v1, s[50:51] offset:-3072
    v_exp_f32 v116, v116
    v_cvt_pk_bf16_f32 v137, v114, v115
    v_exp_f32 v117, v117
    v_exp_f32 v118, v118
    v_exp_f32 v119, v119
    v_cvt_pk_bf16_f32 v138, v116, v117
    v_mfma_f32_32x32x16_bf16 a[0:15], a[168:171], v[128:131], a[0:15]
    global_load_dwordx4 v[216:219], v1, s[50:51] offset:-2048
    v_exp_f32 v120, v120
    v_cvt_pk_bf16_f32 v139, v118, v119
    v_exp_f32 v121, v121
    v_exp_f32 v122, v122
    v_exp_f32 v123, v123
    v_cvt_pk_bf16_f32 v140, v120, v121
    v_mfma_f32_32x32x16_bf16 a[0:15], a[172:175], v[132:135], a[0:15]
    v_exp_f32 v124, v124
    v_cvt_pk_bf16_f32 v141, v122, v123
    v_exp_f32 v125, v125
    v_exp_f32 v126, v126
    v_exp_f32 v127, v127
    v_cvt_pk_bf16_f32 v142, v124, v125
    v_cvt_pk_bf16_f32 v143, v126, v127
    v_mfma_f32_32x32x16_bf16 v[112:127], a[160:163], v[56:59], 0
    global_load_dwordx4 v[220:223], v1, s[50:51] offset:-1024
    v_exp_f32 v96, v96
    v_exp_f32 v97, v97
    v_exp_f32 v98, v98
    v_exp_f32 v99, v99
    v_cvt_pk_bf16_f32 v128, v96, v97
    v_mfma_f32_32x32x16_bf16 v[112:127], a[164:167], v[60:63], v[112:127]
    v_exp_f32 v100, v100
    v_cvt_pk_bf16_f32 v129, v98, v99
    v_exp_f32 v101, v101
    v_exp_f32 v102, v102
    v_exp_f32 v103, v103
    v_cvt_pk_bf16_f32 v130, v100, v101
    v_mfma_f32_32x32x16_bf16 a[16:31], a[168:171], v[136:139], a[16:31]
    global_load_dword v4, v10, s[56:57] offset:0
    v_exp_f32 v104, v104
    v_cvt_pk_bf16_f32 v131, v102, v103
    v_exp_f32 v105, v105
    v_exp_f32 v106, v106
    v_exp_f32 v107, v107
    v_cvt_pk_bf16_f32 v132, v104, v105
    v_mfma_f32_32x32x16_bf16 a[16:31], a[172:175], v[140:143], a[16:31]
    global_load_dwordx4 a[48:51], v1, s[50:51] offset:0
    v_exp_f32 v108, v108
    v_cvt_pk_bf16_f32 v133, v106, v107
    v_exp_f32 v109, v109
    v_exp_f32 v110, v110
    v_exp_f32 v111, v111
    v_cvt_pk_bf16_f32 v134, v108, v109
    v_cvt_pk_bf16_f32 v135, v110, v111
    v_mfma_f32_32x32x16_bf16 v[96:111], a[176:179], v[32:35], 0
    global_load_dwordx4 a[52:55], v1, s[50:51] offset:1024
    v_exp_f32 v112, v112
    v_exp_f32 v113, v113
    v_exp_f32 v114, v114
    v_exp_f32 v115, v115
    v_cvt_pk_bf16_f32 v136, v112, v113
    v_mfma_f32_32x32x16_bf16 v[96:111], a[180:183], v[36:39], v[96:111]
    v_exp_f32 v116, v116
    v_cvt_pk_bf16_f32 v137, v114, v115
    v_exp_f32 v117, v117
    v_exp_f32 v118, v118
    v_exp_f32 v119, v119
    v_cvt_pk_bf16_f32 v138, v116, v117
    v_mfma_f32_32x32x16_bf16 a[32:47], a[168:171], v[128:131], a[32:47]
    global_load_dwordx4 a[56:59], v1, s[50:51] offset:2048
    v_exp_f32 v120, v120
    v_cvt_pk_bf16_f32 v139, v118, v119
    v_exp_f32 v121, v121
    v_exp_f32 v122, v122
    v_exp_f32 v123, v123
    v_cvt_pk_bf16_f32 v140, v120, v121
    v_mfma_f32_32x32x16_bf16 a[32:47], a[172:175], v[132:135], a[32:47]
    global_load_dwordx4 a[60:63], v1, s[50:51] offset:3072
    v_exp_f32 v124, v124
    v_cvt_pk_bf16_f32 v141, v122, v123
    v_exp_f32 v125, v125
    v_exp_f32 v126, v126
    v_exp_f32 v127, v127
    v_cvt_pk_bf16_f32 v142, v124, v125
    v_cvt_pk_bf16_f32 v143, v126, v127
    v_mfma_f32_32x32x16_bf16 v[112:127], a[176:179], v[40:43], 0
    v_exp_f32 v96, v96
    v_exp_f32 v97, v97
    v_exp_f32 v98, v98
    v_exp_f32 v99, v99
    v_cvt_pk_bf16_f32 v128, v96, v97
    v_mfma_f32_32x32x16_bf16 v[112:127], a[180:183], v[44:47], v[112:127]
    s_load_dword s88, s[66:67], 128 glc
    s_load_dword s89, s[66:67], 256 glc
    s_load_dword s90, s[66:67], 384 glc
    v_exp_f32 v100, v100
    v_cvt_pk_bf16_f32 v129, v98, v99
    v_exp_f32 v101, v101
    v_exp_f32 v102, v102
    v_exp_f32 v103, v103
    v_cvt_pk_bf16_f32 v130, v100, v101
    v_mfma_f32_32x32x16_bf16 v[224:239], a[168:171], v[136:139], v[224:239]
    global_load_dwordx4 a[224:227], v7, s[50:51] offset:-4096
    v_exp_f32 v104, v104
    v_cvt_pk_bf16_f32 v131, v102, v103
    v_exp_f32 v105, v105
    v_exp_f32 v106, v106
    v_exp_f32 v107, v107
    v_cvt_pk_bf16_f32 v132, v104, v105
    v_mfma_f32_32x32x16_bf16 v[224:239], a[172:175], v[140:143], v[224:239]
    v_exp_f32 v108, v108
    v_cvt_pk_bf16_f32 v133, v106, v107
    v_exp_f32 v109, v109
    v_exp_f32 v110, v110
    v_exp_f32 v111, v111
    v_cvt_pk_bf16_f32 v134, v108, v109
    v_cvt_pk_bf16_f32 v135, v110, v111
    v_mfma_f32_32x32x16_bf16 v[96:111], a[176:179], v[48:51], 0
    global_load_dwordx4 a[228:231], v7, s[50:51] offset:-3072
    v_exp_f32 v112, v112
    v_exp_f32 v113, v113
    v_exp_f32 v114, v114
    v_exp_f32 v115, v115
    v_cvt_pk_bf16_f32 v136, v112, v113
    v_mfma_f32_32x32x16_bf16 v[96:111], a[180:183], v[52:55], v[96:111]
    global_load_dwordx4 a[232:235], v7, s[50:51] offset:-2048
    v_exp_f32 v116, v116
    v_cvt_pk_bf16_f32 v137, v114, v115
    v_exp_f32 v117, v117
    v_exp_f32 v118, v118
    v_exp_f32 v119, v119
    v_cvt_pk_bf16_f32 v138, v116, v117
    v_mfma_f32_32x32x16_bf16 a[0:15], a[184:187], v[128:131], a[0:15]
    global_load_dword v4, v10, s[56:57] offset:2048
    v_exp_f32 v120, v120
    v_cvt_pk_bf16_f32 v139, v118, v119
    v_exp_f32 v121, v121
    v_exp_f32 v122, v122
    v_exp_f32 v123, v123
    v_cvt_pk_bf16_f32 v140, v120, v121
    v_mfma_f32_32x32x16_bf16 a[0:15], a[188:191], v[132:135], a[0:15]
    v_exp_f32 v124, v124
    v_cvt_pk_bf16_f32 v141, v122, v123
    v_exp_f32 v125, v125
    v_exp_f32 v126, v126
    v_exp_f32 v127, v127
    v_cvt_pk_bf16_f32 v142, v124, v125
    v_cvt_pk_bf16_f32 v143, v126, v127
    v_mfma_f32_32x32x16_bf16 v[112:127], a[176:179], v[56:59], 0
    global_load_dwordx4 a[236:239], v7, s[50:51] offset:-1024
    v_exp_f32 v96, v96
    v_exp_f32 v97, v97
    v_exp_f32 v98, v98
    v_exp_f32 v99, v99
    v_cvt_pk_bf16_f32 v128, v96, v97
    v_mfma_f32_32x32x16_bf16 v[112:127], a[180:183], v[60:63], v[112:127]
    global_load_dwordx4 a[240:243], v7, s[50:51] offset:0
    v_exp_f32 v100, v100
    v_cvt_pk_bf16_f32 v129, v98, v99
    v_exp_f32 v101, v101
    v_exp_f32 v102, v102
    v_exp_f32 v103, v103
    v_cvt_pk_bf16_f32 v130, v100, v101
    v_mfma_f32_32x32x16_bf16 a[16:31], a[184:187], v[136:139], a[16:31]
    v_exp_f32 v104, v104
    v_cvt_pk_bf16_f32 v131, v102, v103
    v_exp_f32 v105, v105
    v_exp_f32 v106, v106
    v_exp_f32 v107, v107
    v_cvt_pk_bf16_f32 v132, v104, v105
    v_mfma_f32_32x32x16_bf16 a[16:31], a[188:191], v[140:143], a[16:31]
    global_load_dwordx4 a[244:247], v7, s[50:51] offset:1024
    v_exp_f32 v108, v108
    v_cvt_pk_bf16_f32 v133, v106, v107
    v_exp_f32 v109, v109
    v_exp_f32 v110, v110
    v_exp_f32 v111, v111
    v_cvt_pk_bf16_f32 v134, v108, v109
    v_cvt_pk_bf16_f32 v135, v110, v111
    v_mfma_f32_32x32x16_bf16 v[96:111], a[192:195], v[32:35], 0
    v_exp_f32 v112, v112
    v_exp_f32 v113, v113
    v_exp_f32 v114, v114
    v_exp_f32 v115, v115
    v_cvt_pk_bf16_f32 v136, v112, v113
    v_mfma_f32_32x32x16_bf16 v[96:111], a[196:199], v[36:39], v[96:111]
    global_load_dwordx4 a[248:251], v7, s[50:51] offset:2048
    v_exp_f32 v116, v116
    v_cvt_pk_bf16_f32 v137, v114, v115
    v_exp_f32 v117, v117
    v_exp_f32 v118, v118
    v_exp_f32 v119, v119
    v_cvt_pk_bf16_f32 v138, v116, v117
    v_mfma_f32_32x32x16_bf16 a[32:47], a[184:187], v[128:131], a[32:47]
    global_load_dwordx4 a[252:255], v7, s[50:51] offset:3072
    v_exp_f32 v120, v120
    v_cvt_pk_bf16_f32 v139, v118, v119
    v_exp_f32 v121, v121
    v_exp_f32 v122, v122
    v_exp_f32 v123, v123
    v_cvt_pk_bf16_f32 v140, v120, v121
    v_mfma_f32_32x32x16_bf16 a[32:47], a[188:191], v[132:135], a[32:47]
    v_exp_f32 v124, v124
    v_cvt_pk_bf16_f32 v141, v122, v123
    v_exp_f32 v125, v125
    v_exp_f32 v126, v126
    v_exp_f32 v127, v127
    v_cvt_pk_bf16_f32 v142, v124, v125
    v_cvt_pk_bf16_f32 v143, v126, v127
    v_mfma_f32_32x32x16_bf16 v[112:127], a[192:195], v[40:43], 0
    global_load_dwordx4 a[64:67], v1, s[96:97] offset:-4096
    v_exp_f32 v96, v96
    v_exp_f32 v97, v97
    v_exp_f32 v98, v98
    v_exp_f32 v99, v99
    v_cvt_pk_bf16_f32 v128, v96, v97
    v_mfma_f32_32x32x16_bf16 v[112:127], a[196:199], v[44:47], v[112:127]
    global_load_dwordx4 a[68:71], v1, s[96:97] offset:-3072
    v_exp_f32 v100, v100
    v_cvt_pk_bf16_f32 v129, v98, v99
    v_exp_f32 v101, v101
    v_exp_f32 v102, v102
    v_exp_f32 v103, v103
    v_cvt_pk_bf16_f32 v130, v100, v101
    v_mfma_f32_32x32x16_bf16 v[224:239], a[184:187], v[136:139], v[224:239]
    global_load_dword v4, v11, s[56:57] offset:-4096
    v_exp_f32 v104, v104
    v_cvt_pk_bf16_f32 v131, v102, v103
    v_exp_f32 v105, v105
    v_exp_f32 v106, v106
    v_exp_f32 v107, v107
    v_cvt_pk_bf16_f32 v132, v104, v105
    v_mfma_f32_32x32x16_bf16 v[224:239], a[188:191], v[140:143], v[224:239]
    v_exp_f32 v108, v108
    v_cvt_pk_bf16_f32 v133, v106, v107
    v_exp_f32 v109, v109
    v_exp_f32 v110, v110
    v_exp_f32 v111, v111
    v_cvt_pk_bf16_f32 v134, v108, v109
    v_cvt_pk_bf16_f32 v135, v110, v111
    v_mfma_f32_32x32x16_bf16 v[96:111], a[192:195], v[48:51], 0
    global_load_dwordx4 a[72:75], v1, s[96:97] offset:-2048
    v_exp_f32 v112, v112
    v_exp_f32 v113, v113
    v_exp_f32 v114, v114
    v_exp_f32 v115, v115
    v_cvt_pk_bf16_f32 v136, v112, v113
    v_mfma_f32_32x32x16_bf16 v[96:111], a[196:199], v[52:55], v[96:111]
    v_exp_f32 v116, v116
    v_cvt_pk_bf16_f32 v137, v114, v115
    v_exp_f32 v117, v117
    v_exp_f32 v118, v118
    v_exp_f32 v119, v119
    v_cvt_pk_bf16_f32 v138, v116, v117
    v_mfma_f32_32x32x16_bf16 a[0:15], a[200:203], v[128:131], a[0:15]
    global_load_dwordx4 a[76:79], v1, s[96:97] offset:-1024
    v_exp_f32 v120, v120
    v_cvt_pk_bf16_f32 v139, v118, v119
    v_exp_f32 v121, v121
    v_exp_f32 v122, v122
    v_exp_f32 v123, v123
    v_cvt_pk_bf16_f32 v140, v120, v121
    v_mfma_f32_32x32x16_bf16 a[0:15], a[204:207], v[132:135], a[0:15]
    global_load_dwordx4 a[80:83], v1, s[96:97] offset:0
    v_exp_f32 v124, v124
    v_cvt_pk_bf16_f32 v141, v122, v123
    v_exp_f32 v125, v125
    v_exp_f32 v126, v126
    v_exp_f32 v127, v127
    v_cvt_pk_bf16_f32 v142, v124, v125
    v_cvt_pk_bf16_f32 v143, v126, v127
    v_mfma_f32_32x32x16_bf16 v[112:127], a[192:195], v[56:59], 0
    v_exp_f32 v96, v96
    v_exp_f32 v97, v97
    v_exp_f32 v98, v98
    v_exp_f32 v99, v99
    v_cvt_pk_bf16_f32 v128, v96, v97
    v_mfma_f32_32x32x16_bf16 v[112:127], a[196:199], v[60:63], v[112:127]
    global_load_dwordx4 a[84:87], v1, s[96:97] offset:1024
    v_exp_f32 v100, v100
    v_cvt_pk_bf16_f32 v129, v98, v99
    v_exp_f32 v101, v101
    v_exp_f32 v102, v102
    v_exp_f32 v103, v103
    v_cvt_pk_bf16_f32 v130, v100, v101
    v_mfma_f32_32x32x16_bf16 a[16:31], a[200:203], v[136:139], a[16:31]
    global_load_dwordx4 a[88:91], v1, s[96:97] offset:2048
    v_exp_f32 v104, v104
    v_cvt_pk_bf16_f32 v131, v102, v103
    v_exp_f32 v105, v105
    v_exp_f32 v106, v106
    v_exp_f32 v107, v107
    v_cvt_pk_bf16_f32 v132, v104, v105
    v_mfma_f32_32x32x16_bf16 a[16:31], a[204:207], v[140:143], a[16:31]
    v_exp_f32 v108, v108
    v_cvt_pk_bf16_f32 v133, v106, v107
    v_exp_f32 v109, v109
    v_exp_f32 v110, v110
    v_exp_f32 v111, v111
    v_cvt_pk_bf16_f32 v134, v108, v109
    v_cvt_pk_bf16_f32 v135, v110, v111
    v_mfma_f32_32x32x16_bf16 v[96:111], v[64:67], v[32:35], 0
    global_load_dwordx4 a[92:95], v1, s[96:97] offset:3072
    v_exp_f32 v112, v112
    v_exp_f32 v113, v113
    v_exp_f32 v114, v114
    v_exp_f32 v115, v115
    v_cvt_pk_bf16_f32 v136, v112, v113
    v_mfma_f32_32x32x16_bf16 v[96:111], v[68:71], v[36:39], v[96:111]
    v_exp_f32 v116, v116
    v_cvt_pk_bf16_f32 v137, v114, v115
    v_exp_f32 v117, v117
    v_exp_f32 v118, v118
    v_exp_f32 v119, v119
    v_cvt_pk_bf16_f32 v138, v116, v117
    v_mfma_f32_32x32x16_bf16 a[32:47], a[200:203], v[128:131], a[32:47]
    global_load_dword v4, v11, s[56:57] offset:-2048
    v_exp_f32 v120, v120
    v_cvt_pk_bf16_f32 v139, v118, v119
    v_exp_f32 v121, v121
    v_exp_f32 v122, v122
    v_exp_f32 v123, v123
    v_cvt_pk_bf16_f32 v140, v120, v121
    v_mfma_f32_32x32x16_bf16 a[32:47], a[204:207], v[132:135], a[32:47]
    global_load_dwordx4 a[96:99], v7, s[96:97] offset:-4096
    v_exp_f32 v124, v124
    v_cvt_pk_bf16_f32 v141, v122, v123
    v_exp_f32 v125, v125
    v_exp_f32 v126, v126
    v_exp_f32 v127, v127
    v_cvt_pk_bf16_f32 v142, v124, v125
    v_cvt_pk_bf16_f32 v143, v126, v127
    v_mfma_f32_32x32x16_bf16 v[112:127], v[80:83], v[32:35], 0
    global_load_dwordx4 a[100:103], v7, s[96:97] offset:-3072
    v_exp_f32 v96, v96
    v_exp_f32 v97, v97
    v_exp_f32 v98, v98
    v_exp_f32 v99, v99
    v_cvt_pk_bf16_f32 v128, v96, v97
    v_mfma_f32_32x32x16_bf16 v[112:127], v[84:87], v[36:39], v[112:127]
    v_exp_f32 v100, v100
    v_cvt_pk_bf16_f32 v129, v98, v99
    v_exp_f32 v101, v101
    v_exp_f32 v102, v102
    v_exp_f32 v103, v103
    v_cvt_pk_bf16_f32 v130, v100, v101
    v_mfma_f32_32x32x16_bf16 v[224:239], a[200:203], v[136:139], v[224:239]
    s_branch KA_sk3
KA_t3:
    s_branch KA_tret
KA_sk3:
    global_load_dwordx4 a[104:107], v7, s[96:97] offset:-2048
    v_exp_f32 v104, v104
    v_cvt_pk_bf16_f32 v131, v102, v103
    v_exp_f32 v105, v105
    v_exp_f32 v106, v106
    v_exp_f32 v107, v107
    v_cvt_pk_bf16_f32 v132, v104, v105
    v_mfma_f32_32x32x16_bf16 v[224:239], a[204:207], v[140:143], v[224:239]
    global_load_dwordx4 a[108:111], v7, s[96:97] offset:-1024
    v_exp_f32 v108, v108
    v_cvt_pk_bf16_f32 v133, v106, v107
    v_exp_f32 v109, v109
    v_exp_f32 v110, v110
    v_exp_f32 v111, v111
    v_cvt_pk_bf16_f32 v134, v108, v109
    v_cvt_pk_bf16_f32 v135, v110, v111
    v_mfma_f32_32x32x16_bf16 v[96:111], v[240:243], v[32:35], 0
    v_exp_f32 v112, v112
    v_exp_f32 v113, v113
    v_exp_f32 v114, v114
    v_exp_f32 v115, v115
    v_cvt_pk_bf16_f32 v136, v112, v113
    v_mfma_f32_32x32x16_bf16 v[96:111], v[244:247], v[36:39], v[96:111]
    global_load_dwordx4 a[112:115], v7, s[96:97] offset:0
    v_exp_f32 v116, v116
    v_cvt_pk_bf16_f32 v137, v114, v115
    v_exp_f32 v117, v117
    v_exp_f32 v118, v118
    v_exp_f32 v119, v119
    v_cvt_pk_bf16_f32 v138, v116, v117
    v_mfma_f32_32x32x16_bf16 a[0:15], v[72:75], v[128:131], a[0:15]
    v_exp_f32 v120, v120
    v_cvt_pk_bf16_f32 v139, v118, v119
    v_exp_f32 v121, v121
    v_exp_f32 v122, v122
    v_exp_f32 v123, v123
    v_cvt_pk_bf16_f32 v140, v120, v121
    v_mfma_f32_32x32x16_bf16 a[0:15], v[76:79], v[132:135], a[0:15]
    global_load_dwordx4 a[116:119], v7, s[96:97] offset:1024
    v_exp_f32 v124, v124
    v_cvt_pk_bf16_f32 v141, v122, v123
    v_exp_f32 v125, v125
    v_exp_f32 v126, v126
    v_exp_f32 v127, v127
    v_cvt_pk_bf16_f32 v142, v124, v125
    v_cvt_pk_bf16_f32 v143, v126, v127
    v_mfma_f32_32x32x16_bf16 v[112:127], a[208:211], v[32:35], 0
    global_load_dwordx4 a[120:123], v7, s[96:97] offset:2048
    v_exp_f32 v96, v96
    v_exp_f32 v97, v97
    v_exp_f32 v98, v98
    v_exp_f32 v99, v99
    v_cvt_pk_bf16_f32 v128, v96, v97
    v_mfma_f32_32x32x16_bf16 v[112:127], a[212:215], v[36:39], v[112:127]
    v_exp_f32 v100, v100
    v_cvt_pk_bf16_f32 v129, v98, v99
    v_exp_f32 v101, v101
    v_exp_f32 v102, v102
    v_exp_f32 v103, v103
    v_cvt_pk_bf16_f32 v130, v100, v101
    v_mfma_f32_32x32x16_bf16 a[0:15], v[88:91], v[136:139], a[0:15]
    global_load_dword v4, v11, s[56:57] offset:0
    v_exp_f32 v104, v104
    v_cvt_pk_bf16_f32 v131, v102, v103
    v_exp_f32 v105, v105
    v_exp_f32 v106, v106
    v_exp_f32 v107, v107
    v_cvt_pk_bf16_f32 v132, v104, v105
    v_mfma_f32_32x32x16_bf16 a[0:15], v[92:95], v[140:143], a[0:15]
    global_load_dwordx4 a[124:127], v7, s[96:97] offset:3072
    v_exp_f32 v108, v108
    v_cvt_pk_bf16_f32 v133, v106, v107
    v_exp_f32 v109, v109
    v_exp_f32 v110, v110
    v_exp_f32 v111, v111
    v_cvt_pk_bf16_f32 v134, v108, v109
    v_cvt_pk_bf16_f32 v135, v110, v111
    v_mfma_f32_32x32x16_bf16 v[96:111], v[64:67], v[40:43], 0
    global_load_dwordx4 a[128:131], v9, s[96:97] offset:-4096
    v_exp_f32 v112, v112
    v_exp_f32 v113, v113
    v_exp_f32 v114, v114
    v_exp_f32 v115, v115
    v_cvt_pk_bf16_f32 v136, v112, v113
    v_mfma_f32_32x32x16_bf16 v[96:111], v[68:71], v[44:47], v[96:111]
    v_exp_f32 v116, v116
    v_cvt_pk_bf16_f32 v137, v114, v115
    v_exp_f32 v117, v117
    v_exp_f32 v118, v118
    v_exp_f32 v119, v119
    v_cvt_pk_bf16_f32 v138, v116, v117
    v_mfma_f32_32x32x16_bf16 a[0:15], v[248:251], v[128:131], a[0:15]
    global_load_dwordx4 a[132:135], v9, s[96:97] offset:-3072
    v_exp_f32 v120, v120
    v_cvt_pk_bf16_f32 v139, v118, v119
    v_exp_f32 v121, v121
    v_exp_f32 v122, v122
    v_exp_f32 v123, v123
    v_cvt_pk_bf16_f32 v140, v120, v121
    v_mfma_f32_32x32x16_bf16 a[0:15], v[252:255], v[132:135], a[0:15]
    v_exp_f32 v124, v124
    v_cvt_pk_bf16_f32 v141, v122, v123
    v_exp_f32 v125, v125
    v_exp_f32 v126, v126
    v_exp_f32 v127, v127
    v_cvt_pk_bf16_f32 v142, v124, v125
    v_cvt_pk_bf16_f32 v143, v126, v127
    v_mfma_f32_32x32x16_bf16 v[112:127], v[80:83], v[40:43], 0
    global_load_dwordx4 a[136:139], v9, s[96:97] offset:-2048
    v_exp_f32 v96, v96
    v_exp_f32 v97, v97
    v_exp_f32 v98, v98
    v_exp_f32 v99, v99
    v_cvt_pk_bf16_f32 v128, v96, v97
    v_mfma_f32_32x32x16_bf16 v[112:127], v[84:87], v[44:47], v[112:127]
    global_load_dwordx4 a[140:143], v9, s[96:97] offset:-1024
    v_exp_f32 v100, v100
    v_cvt_pk_bf16_f32 v129, v98, v99
    v_exp_f32 v101, v101
    v_exp_f32 v102, v102
    v_exp_f32 v103, v103
    v_cvt_pk_bf16_f32 v130, v100, v101
    v_mfma_f32_32x32x16_bf16 a[0:15], a[216:219], v[136:139], a[0:15]
    v_exp_f32 v104, v104
    v_cvt_pk_bf16_f32 v131, v102, v103
    v_exp_f32 v105, v105
    v_exp_f32 v106, v106
    v_exp_f32 v107, v107
    v_cvt_pk_bf16_f32 v132, v104, v105
    v_mfma_f32_32x32x16_bf16 a[0:15], a[220:223], v[140:143], a[0:15]
    global_load_dwordx4 a[144:147], v9, s[96:97] offset:0
    v_exp_f32 v108, v108
    v_cvt_pk_bf16_f32 v133, v106, v107
    v_exp_f32 v109, v109
    v_exp_f32 v110, v110
    v_exp_f32 v111, v111
    v_cvt_pk_bf16_f32 v134, v108, v109
    v_cvt_pk_bf16_f32 v135, v110, v111
    v_mfma_f32_32x32x16_bf16 v[96:111], v[240:243], v[40:43], 0
    global_load_dwordx4 a[148:151], v9, s[96:97] offset:1024
    v_exp_f32 v112, v112
    v_exp_f32 v113, v113
    v_exp_f32 v114, v114
    v_exp_f32 v115, v115
    v_cvt_pk_bf16_f32 v136, v112, v113
    v_mfma_f32_32x32x16_bf16 v[96:111], v[244:247], v[44:47], v[96:111]
    ds_write_b128 v13, a[0:3] offset:0
    v_exp_f32 v116, v116
    v_cvt_pk_bf16_f32 v137, v114, v115
    v_exp_f32 v117, v117
    v_exp_f32 v118, v118
    v_exp_f32 v119, v119
    v_cvt_pk_bf16_f32 v138, v116, v117
    v_mfma_f32_32x32x16_bf16 a[16:31], v[72:75], v[128:131], a[16:31]
    ds_write_b128 v13, a[4:7] offset:1024
    v_exp_f32 v120, v120
    v_cvt_pk_bf16_f32 v139, v118, v119
    v_exp_f32 v121, v121
    v_exp_f32 v122, v122
    v_exp_f32 v123, v123
    v_cvt_pk_bf16_f32 v140, v120, v121
    v_mfma_f32_32x32x16_bf16 a[16:31], v[76:79], v[132:135], a[16:31]
    ds_write_b128 v13, a[8:11] offset:2048
    v_exp_f32 v124, v124
    v_cvt_pk_bf16_f32 v141, v122, v123
    v_exp_f32 v125, v125
    v_exp_f32 v126, v126
    v_exp_f32 v127, v127
    v_cvt_pk_bf16_f32 v142, v124, v125
    v_cvt_pk_bf16_f32 v143, v126, v127
    v_mfma_f32_32x32x16_bf16 v[112:127], a[208:211], v[40:43], 0
    ds_write_b128 v13, a[12:15] offset:3072
    v_exp_f32 v96, v96
    v_exp_f32 v97, v97
    v_exp_f32 v98, v98
    v_exp_f32 v99, v99
    v_cvt_pk_bf16_f32 v128, v96, v97
    v_mfma_f32_32x32x16_bf16 v[112:127], a[212:215], v[44:47], v[112:127]
    v_exp_f32 v100, v100
    v_cvt_pk_bf16_f32 v129, v98, v99
    v_exp_f32 v101, v101
    v_exp_f32 v102, v102
    v_exp_f32 v103, v103
    v_cvt_pk_bf16_f32 v130, v100, v101
    v_mfma_f32_32x32x16_bf16 a[16:31], v[88:91], v[136:139], a[16:31]
    global_load_dwordx4 a[152:155], v9, s[96:97] offset:2048
    v_exp_f32 v104, v104
    v_cvt_pk_bf16_f32 v131, v102, v103
    v_exp_f32 v105, v105
    v_exp_f32 v106, v106
    v_exp_f32 v107, v107
    v_cvt_pk_bf16_f32 v132, v104, v105
    v_mfma_f32_32x32x16_bf16 a[16:31], v[92:95], v[140:143], a[16:31]
    v_exp_f32 v108, v108
    v_cvt_pk_bf16_f32 v133, v106, v107
    v_exp_f32 v109, v109
    v_exp_f32 v110, v110
    v_exp_f32 v111, v111
    v_cvt_pk_bf16_f32 v134, v108, v109
    v_cvt_pk_bf16_f32 v135, v110, v111
    v_mfma_f32_32x32x16_bf16 v[96:111], v[64:67], v[48:51], 0
    s_waitcnt vmcnt(48)
    global_load_dwordx4 a[156:159], v9, s[96:97] offset:3072
    v_exp_f32 v112, v112
    v_exp_f32 v113, v113
    v_exp_f32 v114, v114
    v_exp_f32 v115, v115
    v_cvt_pk_bf16_f32 v136, v112, v113
    v_mfma_f32_32x32x16_bf16 v[96:111], v[68:71], v[52:55], v[96:111]
    global_load_dwordx4 a[160:163], v8, s[96:97] offset:-4096
    v_exp_f32 v116, v116
    v_cvt_pk_bf16_f32 v137, v114, v115
    v_exp_f32 v117, v117
    v_exp_f32 v118, v118
    v_exp_f32 v119, v119
    v_cvt_pk_bf16_f32 v138, v116, v117
    v_mfma_f32_32x32x16_bf16 a[16:31], v[248:251], v[128:131], a[16:31]
    v_exp_f32 v120, v120
    v_cvt_pk_bf16_f32 v139, v118, v119
    v_exp_f32 v121, v121
    v_exp_f32 v122, v122
    v_exp_f32 v123, v123
    v_cvt_pk_bf16_f32 v140, v120, v121
    v_mfma_f32_32x32x16_bf16 a[16:31], v[252:255], v[132:135], a[16:31]
    global_load_dwordx4 a[164:167], v8, s[96:97] offset:-3072
    v_exp_f32 v124, v124
    v_cvt_pk_bf16_f32 v141, v122, v123
    v_exp_f32 v125, v125
    v_exp_f32 v126, v126
    v_exp_f32 v127, v127
    v_cvt_pk_bf16_f32 v142, v124, v125
    v_cvt_pk_bf16_f32 v143, v126, v127
    v_mfma_f32_32x32x16_bf16 v[112:127], v[80:83], v[48:51], 0
    global_load_dwordx4 a[168:171], v8, s[96:97] offset:-2048
    v_exp_f32 v96, v96
    v_exp_f32 v97, v97
    v_exp_f32 v98, v98
    v_exp_f32 v99, v99
    v_cvt_pk_bf16_f32 v128, v96, v97
    v_mfma_f32_32x32x16_bf16 v[112:127], v[84:87], v[52:55], v[112:127]
    v_exp_f32 v100, v100
    v_cvt_pk_bf16_f32 v129, v98, v99
    v_exp_f32 v101, v101
    v_exp_f32 v102, v102
    v_exp_f32 v103, v103
    v_cvt_pk_bf16_f32 v130, v100, v101
    v_mfma_f32_32x32x16_bf16 a[16:31], a[216:219], v[136:139], a[16:31]
    global_load_dwordx4 a[172:175], v8, s[96:97] offset:-1024
    v_exp_f32 v104, v104
    v_cvt_pk_bf16_f32 v131, v102, v103
    v_exp_f32 v105, v105
    v_exp_f32 v106, v106
    v_exp_f32 v107, v107
    v_cvt_pk_bf16_f32 v132, v104, v105
    v_mfma_f32_32x32x16_bf16 a[16:31], a[220:223], v[140:143], a[16:31]
    v_exp_f32 v108, v108
    v_cvt_pk_bf16_f32 v133, v106, v107
    v_exp_f32 v109, v109
    v_exp_f32 v110, v110
    v_exp_f32 v111, v111
    v_cvt_pk_bf16_f32 v134, v108, v109
    v_cvt_pk_bf16_f32 v135, v110, v111
    v_mfma_f32_32x32x16_bf16 v[96:111], v[240:243], v[48:51], 0
    global_load_dword v28, v30, s[66:67] offset:0 sc1
    v_exp_f32 v112, v112
    v_exp_f32 v113, v113
    v_exp_f32 v114, v114
    v_exp_f32 v115, v115
    v_cvt_pk_bf16_f32 v136, v112, v113
    v_mfma_f32_32x32x16_bf16 v[96:111], v[244:247], v[52:55], v[96:111]
    ds_write_b128 v14, a[16:19] offset:0
    v_exp_f32 v116, v116
    v_cvt_pk_bf16_f32 v137, v114, v115
    v_exp_f32 v117, v117
    v_exp_f32 v118, v118
    v_exp_f32 v119, v119
    v_cvt_pk_bf16_f32 v138, v116, v117
    v_mfma_f32_32x32x16_bf16 a[32:47], v[72:75], v[128:131], a[32:47]
    ds_write_b128 v14, a[20:23] offset:1024
    v_exp_f32 v120, v120
    v_cvt_pk_bf16_f32 v139, v118, v119
    v_exp_f32 v121, v121
    v_exp_f32 v122, v122
    v_exp_f32 v123, v123
    v_cvt_pk_bf16_f32 v140, v120, v121
    v_mfma_f32_32x32x16_bf16 a[32:47], v[76:79], v[132:135], a[32:47]
    ds_write_b128 v14, a[24:27] offset:2048
    v_exp_f32 v124, v124
    v_cvt_pk_bf16_f32 v141, v122, v123
    v_exp_f32 v125, v125
    v_exp_f32 v126, v126
    v_exp_f32 v127, v127
    v_cvt_pk_bf16_f32 v142, v124, v125
    v_cvt_pk_bf16_f32 v143, v126, v127
    v_mfma_f32_32x32x16_bf16 v[112:127], a[208:211], v[48:51], 0
    ds_write_b128 v14, a[28:31] offset:3072
    v_exp_f32 v96, v96
    v_exp_f32 v97, v97
    v_exp_f32 v98, v98
    v_exp_f32 v99, v99
    v_cvt_pk_bf16_f32 v128, v96, v97
    v_mfma_f32_32x32x16_bf16 v[112:127], a[212:215], v[52:55], v[112:127]
    global_load_dwordx4 v[16:19], v3, s[100:101] offset:0
    v_exp_f32 v100, v100
    v_cvt_pk_bf16_f32 v129, v98, v99
    v_exp_f32 v101, v101
    v_exp_f32 v102, v102
    v_exp_f32 v103, v103
    v_cvt_pk_bf16_f32 v130, v100, v101
    v_mfma_f32_32x32x16_bf16 a[32:47], v[88:91], v[136:139], a[32:47]
    global_load_dwordx4 v[20:23], v3, s[100:101] offset:32
    v_exp_f32 v104, v104
    v_cvt_pk_bf16_f32 v131, v102, v103
    v_exp_f32 v105, v105
    v_exp_f32 v106, v106
    v_exp_f32 v107, v107
    v_cvt_pk_bf16_f32 v132, v104, v105
    v_mfma_f32_32x32x16_bf16 a[32:47], v[92:95], v[140:143], a[32:47]
    s_waitcnt lgkmcnt(0)
    global_load_dwordx4 a[0:3], v7, s[98:99] offset:0
    v_exp_f32 v108, v108
    v_cvt_pk_bf16_f32 v133, v106, v107
    v_exp_f32 v109, v109
    v_exp_f32 v110, v110
    v_exp_f32 v111, v111
    v_cvt_pk_bf16_f32 v134, v108, v109
    v_cvt_pk_bf16_f32 v135, v110, v111
    v_mfma_f32_32x32x16_bf16 v[96:111], v[64:67], v[56:59], 0
    v_exp_f32 v112, v112
    v_exp_f32 v113, v113
    v_exp_f32 v114, v114
    v_exp_f32 v115, v115
    v_cvt_pk_bf16_f32 v136, v112, v113
    v_mfma_f32_32x32x16_bf16 v[96:111], v[68:71], v[60:63], v[96:111]
    global_load_dwordx4 a[4:7], v7, s[98:99] offset:1024
    v_exp_f32 v116, v116
    v_cvt_pk_bf16_f32 v137, v114, v115
    v_exp_f32 v117, v117
    v_exp_f32 v118, v118
    v_exp_f32 v119, v119
    v_cvt_pk_bf16_f32 v138, v116, v117
    v_mfma_f32_32x32x16_bf16 a[32:47], v[248:251], v[128:131], a[32:47]
    global_load_dword v4, v25, s[20:21] sc1
    v_exp_f32 v120, v120
    v_cvt_pk_bf16_f32 v139, v118, v119
    v_exp_f32 v121, v121
    v_exp_f32 v122, v122
    v_exp_f32 v123, v123
    v_cvt_pk_bf16_f32 v140, v120, v121
    v_mfma_f32_32x32x16_bf16 a[32:47], v[252:255], v[132:135], a[32:47]
    global_load_dwordx4 a[8:11], v7, s[98:99] offset:2048
    v_exp_f32 v124, v124
    v_cvt_pk_bf16_f32 v141, v122, v123
    v_exp_f32 v125, v125
    v_exp_f32 v126, v126
    v_exp_f32 v127, v127
    v_cvt_pk_bf16_f32 v142, v124, v125
    v_cvt_pk_bf16_f32 v143, v126, v127
    v_mfma_f32_32x32x16_bf16 v[112:127], v[80:83], v[56:59], 0
    v_exp_f32 v96, v96
    v_exp_f32 v97, v97
    v_exp_f32 v98, v98
    v_exp_f32 v99, v99
    v_cvt_pk_bf16_f32 v128, v96, v97
    v_mfma_f32_32x32x16_bf16 v[112:127], v[84:87], v[60:63], v[112:127]
    global_load_dwordx4 a[12:15], v7, s[98:99] offset:3072
    v_exp_f32 v100, v100
    v_cvt_pk_bf16_f32 v129, v98, v99
    v_exp_f32 v101, v101
    v_exp_f32 v102, v102
    v_exp_f32 v103, v103
    v_cvt_pk_bf16_f32 v130, v100, v101
    v_mfma_f32_32x32x16_bf16 a[32:47], a[216:219], v[136:139], a[32:47]
    global_load_dword v4, v12, s[54:55] sc1
    v_exp_f32 v104, v104
    v_cvt_pk_bf16_f32 v131, v102, v103
    v_exp_f32 v105, v105
    v_exp_f32 v106, v106
    v_exp_f32 v107, v107
    v_cvt_pk_bf16_f32 v132, v104, v105
    v_mfma_f32_32x32x16_bf16 a[32:47], a[220:223], v[140:143], a[32:47]
    v_exp_f32 v108, v108
    v_cvt_pk_bf16_f32 v133, v106, v107
    v_exp_f32 v109, v109
    v_exp_f32 v110, v110
    v_exp_f32 v111, v111
    v_cvt_pk_bf16_f32 v134, v108, v109
    v_cvt_pk_bf16_f32 v135, v110, v111
    v_mfma_f32_32x32x16_bf16 v[96:111], v[240:243], v[56:59], 0
    v_exp_f32 v112, v112
    v_exp_f32 v113, v113
    v_exp_f32 v114, v114
    v_exp_f32 v115, v115
    v_cvt_pk_bf16_f32 v136, v112, v113
    v_mfma_f32_32x32x16_bf16 v[96:111], v[244:247], v[60:63], v[96:111]
    ds_write_b128 v15, a[32:35] offset:0
    v_exp_f32 v116, v116
    v_cvt_pk_bf16_f32 v137, v114, v115
    v_exp_f32 v117, v117
    v_exp_f32 v118, v118
    v_exp_f32 v119, v119
    v_cvt_pk_bf16_f32 v138, v116, v117
    v_mfma_f32_32x32x16_bf16 v[224:239], v[72:75], v[128:131], v[224:239]
    ds_write_b128 v15, a[36:39] offset:1024
    v_exp_f32 v120, v120
    v_cvt_pk_bf16_f32 v139, v118, v119
    v_exp_f32 v121, v121
    v_exp_f32 v122, v122
    v_exp_f32 v123, v123
    v_cvt_pk_bf16_f32 v140, v120, v121
    v_mfma_f32_32x32x16_bf16 v[224:239], v[76:79], v[132:135], v[224:239]
    ds_write_b128 v15, a[40:43] offset:2048
    v_exp_f32 v124, v124
    v_cvt_pk_bf16_f32 v141, v122, v123
    v_exp_f32 v125, v125
    v_exp_f32 v126, v126
    v_exp_f32 v127, v127
    v_cvt_pk_bf16_f32 v142, v124, v125
    v_cvt_pk_bf16_f32 v143, v126, v127
    v_mfma_f32_32x32x16_bf16 v[112:127], a[208:211], v[56:59], 0
    ds_write_b128 v15, a[44:47] offset:3072
    v_exp_f32 v96, v96
    v_exp_f32 v97, v97
    v_exp_f32 v98, v98
    v_exp_f32 v99, v99
    v_cvt_pk_bf16_f32 v128, v96, v97
    v_mfma_f32_32x32x16_bf16 v[112:127], a[212:215], v[60:63], v[112:127]
    v_exp_f32 v100, v100
    v_cvt_pk_bf16_f32 v129, v98, v99
    v_exp_f32 v101, v101
    v_exp_f32 v102, v102
    v_exp_f32 v103, v103
    v_cvt_pk_bf16_f32 v130, v100, v101
    v_mfma_f32_32x32x16_bf16 v[224:239], v[88:91], v[136:139], v[224:239]
    s_mul_i32 s53, s3, 12288
    v_add_u32 v29, s53, v1
    s_waitcnt lgkmcnt(0)
    s_barrier
    v_exp_f32 v104, v104
    v_cvt_pk_bf16_f32 v131, v102, v103
    v_exp_f32 v105, v105
    v_exp_f32 v106, v106
    v_exp_f32 v107, v107
    v_cvt_pk_bf16_f32 v132, v104, v105
    v_mfma_f32_32x32x16_bf16 v[224:239], v[92:95], v[140:143], v[224:239]
    ds_read_b128 v[32:35], v29 offset:0
    ds_read_b128 v[36:39], v29 offset:1024
    ds_read_b128 v[40:43], v29 offset:2048
    v_exp_f32 v108, v108
    v_cvt_pk_bf16_f32 v133, v106, v107
    v_exp_f32 v109, v109
    v_exp_f32 v110, v110
    v_exp_f32 v111, v111
    v_cvt_pk_bf16_f32 v134, v108, v109
    v_cvt_pk_bf16_f32 v135, v110, v111
    ds_read_b128 v[44:47], v29 offset:3072
    ds_read_b128 v[64:67], v29 offset:4096
    v_exp_f32 v112, v112
    v_exp_f32 v113, v113
    v_exp_f32 v114, v114
    v_exp_f32 v115, v115
    v_cvt_pk_bf16_f32 v136, v112, v113
    ds_read_b128 v[68:71], v29 offset:5120
    ds_read_b128 v[72:75], v29 offset:6144
    ds_read_b128 v[76:79], v29 offset:7168
    v_exp_f32 v116, v116
    v_cvt_pk_bf16_f32 v137, v114, v115
    v_exp_f32 v117, v117
    v_exp_f32 v118, v118
    v_exp_f32 v119, v119
    v_cvt_pk_bf16_f32 v138, v116, v117
    v_mfma_f32_32x32x16_bf16 v[224:239], v[248:251], v[128:131], v[224:239]
    ds_read_b128 v[80:83], v29 offset:8192
    ds_read_b128 v[84:87], v29 offset:9216
    v_exp_f32 v120, v120
    v_cvt_pk_bf16_f32 v139, v118, v119
    v_exp_f32 v121, v121
    v_exp_f32 v122, v122
    v_exp_f32 v123, v123
    v_cvt_pk_bf16_f32 v140, v120, v121
    v_mfma_f32_32x32x16_bf16 v[224:239], v[252:255], v[132:135], v[224:239]
    ds_read_b128 v[240:243], v29 offset:10240
    ds_read_b128 v[244:247], v29 offset:11264
    v_exp_f32 v124, v124
    v_cvt_pk_bf16_f32 v141, v122, v123
    v_exp_f32 v125, v125
    v_exp_f32 v126, v126
    v_exp_f32 v127, v127
    v_cvt_pk_bf16_f32 v142, v124, v125
    v_cvt_pk_bf16_f32 v143, v126, v127
    s_nop 0
    v_mfma_f32_32x32x16_bf16 v[224:239], a[216:219], v[136:139], v[224:239]
    s_waitcnt lgkmcnt(4)
    v_pk_add_f32 v[32:33], v[32:33], v[64:65]
    v_pk_add_f32 v[34:35], v[34:35], v[66:67]
    v_pk_add_f32 v[36:37], v[36:37], v[68:69]
    v_pk_add_f32 v[38:39], v[38:39], v[70:71]
    v_pk_add_f32 v[40:41], v[40:41], v[72:73]
    v_pk_add_f32 v[42:43], v[42:43], v[74:75]
    v_pk_add_f32 v[44:45], v[44:45], v[76:77]
    v_pk_add_f32 v[46:47], v[46:47], v[78:79]
    v_mfma_f32_32x32x16_bf16 v[224:239], a[220:223], v[140:143], v[224:239]
    s_waitcnt lgkmcnt(0)
    v_pk_add_f32 v[32:33], v[32:33], v[80:81]
    v_pk_add_f32 v[34:35], v[34:35], v[82:83]
    v_pk_add_f32 v[36:37], v[36:37], v[84:85]
    v_pk_add_f32 v[38:39], v[38:39], v[86:87]
    v_pk_add_f32 v[40:41], v[40:41], v[240:241]
    v_pk_add_f32 v[42:43], v[42:43], v[242:243]
    v_pk_add_f32 v[44:45], v[44:45], v[244:245]
    v_pk_add_f32 v[46:47], v[46:47], v[246:247]
KB_red:
    s_waitcnt vmcnt(8)
    s_mov_b32 s68, 1
    v_cmp_ne_u32 vcc, s69, v28
    s_cbranch_vccnz KB_xcc
KB_xcc_done:
    s_lshl_b32 s53, s5, 2
    s_add_u32 s53, s53, s3
    v_mov_b32 v10, s53
    v_mov_b32 v11, 1
    v_pk_add_f32 v[44:45], v[44:45], v[236:237]
    v_mov_b32 v14, 0
    v_mov_b32 v12, v44
    v_mov_b32 v13, v44
    v_pk_add_f32 v[46:47], v[46:47], v[238:239]
    v_pk_add_f32 v[32:33], v[32:33], v[224:225]
    v_permlane32_swap_b32 v12, v13
    v_pk_add_f32 v[34:35], v[34:35], v[226:227]
    v_pk_add_f32 v[36:37], v[36:37], v[228:229]
    v_rcp_f32 v12, v13
    v_pk_add_f32 v[38:39], v[38:39], v[230:231]
    v_pk_add_f32 v[40:41], v[40:41], v[232:233]
    v_pk_add_f32 v[42:43], v[42:43], v[234:235]
KB_norm:
    s_cmp_eq_u32 s68, 0
    v_pk_mul_f32 v[32:33], v[32:33], v[12:13] op_sel_hi:[1,0]
    v_pk_mul_f32 v[34:35], v[34:35], v[12:13] op_sel_hi:[1,0]
    v_pk_mul_f32 v[36:37], v[36:37], v[12:13] op_sel_hi:[1,0]
    v_pk_mul_f32 v[38:39], v[38:39], v[12:13] op_sel_hi:[1,0]
    s_cbranch_scc1 KB_ost_fence
    v_cvt_pk_bf16_f32 v48, v32, v33
    v_cvt_pk_bf16_f32 v49, v34, v35
    v_cvt_pk_bf16_f32 v50, v36, v37
    v_cvt_pk_bf16_f32 v51, v38, v39
    global_store_dwordx4 v24, v[48:51], s[20:21] offset:0
    v_pk_mul_f32 v[40:41], v[40:41], v[12:13] op_sel_hi:[1,0]
    v_pk_mul_f32 v[42:43], v[42:43], v[12:13] op_sel_hi:[1,0]
    v_pk_mul_f32 v[44:45], v[44:45], v[12:13] op_sel_hi:[1,0]
    v_pk_mul_f32 v[46:47], v[46:47], v[12:13] op_sel_hi:[1,0]
    v_cvt_pk_bf16_f32 v52, v40, v41
    v_cvt_pk_bf16_f32 v53, v42, v43
    v_cvt_pk_bf16_f32 v54, v44, v45
    v_cvt_pk_bf16_f32 v55, v46, v47
    global_store_dwordx4 v24, v[52:55], s[20:21] offset:1024
KB_ost_done:
    v_dot2c_f32_bf16 v13, 0, v48
    v_dot2c_f32_bf16 v14, 0, v49
    v_dot2c_f32_bf16 v13, 0, v50
    v_dot2c_f32_bf16 v14, 0, v51
    v_dot2c_f32_bf16 v13, 0, v52
    v_dot2c_f32_bf16 v14, 0, v53
    v_dot2c_f32_bf16 v13, 0, v54
    v_dot2c_f32_bf16 v14, 0, v55
    s_nop 2
    v_add_f32 v13, v13, v14
    v_subrev_u32 v13, 0x2b800000, v13
    v_cmp_lt_u32 vcc, 0x46000000, v13
    s_mul_i32 s53, s3, 4096
    s_and_b64 vcc, vcc, s[0:1]
    s_cbranch_vccnz KB_slow
    s_waitcnt vmcnt(8)
    v_permlane32_swap_b32 v16, v18
    v_permlane32_swap_b32 v17, v19
    v_permlane32_swap_b32 v20, v22
    v_permlane32_swap_b32 v21, v23
    s_add_u32 s53, s53, 49152
    v_add_u32 v14, s53, v1
    v_xor_b32 v15, 4096, v14
    v_lshlrev_b32 v96, 16, v16
    v_and_b32 v97, 0xffff0000, v16
    v_lshlrev_b32 v98, 16, v17
    v_and_b32 v99, 0xffff0000, v17
    v_lshlrev_b32 v100, 16, v18
    v_and_b32 v101, 0xffff0000, v18
    v_lshlrev_b32 v102, 16, v19
    v_and_b32 v103, 0xffff0000, v19
    v_lshlrev_b32 v104, 16, v20
    v_and_b32 v105, 0xffff0000, v20
    v_lshlrev_b32 v106, 16, v21
    v_and_b32 v107, 0xffff0000, v21
    v_lshlrev_b32 v108, 16, v22
    v_and_b32 v109, 0xffff0000, v22
    v_lshlrev_b32 v110, 16, v23
    v_and_b32 v111, 0xffff0000, v23
    s_waitcnt vmcnt(0)
    s_cmp_eq_u32 s68, 0
    s_cbranch_scc1 KB_sg0_fence
    s_mov_b64 exec, 1
    global_store_byte v10, v11, s[66:67] offset:128
    s_mov_b64 exec, -1
KB_sg0_done:
    s_cmp_eq_u32 s5, 7
    s_cbranch_scc1 KB_m7
    s_mul_i32 s53, s3, 3*112*1024
    s_lshl_b32 s61, s28, 14
    s_add_u32 s53, s53, s61
    s_add_u32 s53, s53, 5246976
    s_add_u32 s32, s8, s53
    s_addc_u32 s33, s9, 0
    s_add_u32 s34, s32, 114688
    s_addc_u32 s35, s33, 0
    s_add_u32 s36, s34, 114688
    s_addc_u32 s37, s35, 0
    s_add_u32 s53, s15, 12
    s_mul_i32 s53, s53, 112*1024
    s_add_u32 s53, s53, s61
    s_add_u32 s53, s53, 5246976
    s_add_u32 s38, s8, s53
    s_addc_u32 s39, s9, 0
    s_add_u32 s70, s32, 4096
    s_addc_u32 s71, s33, 0
    s_lshl_b32 s60, s3, 14
    s_add_u32 s60, s60, 98304
    s_mov_b32 s52, 0
    s_cmp_eq_u32 s68, 0
    s_cbranch_scc1 KB_pl0_fence
    global_load_dword v31, v30, s[66:67] offset:128 sc1
    global_load_dwordx4 a[176:179], v1, s[98:99] offset:-4096
    global_load_dwordx4 a[180:183], v1, s[98:99] offset:-3072
    global_load_dwordx4 a[184:187], v1, s[98:99] offset:-2048
    global_load_dwordx4 a[188:191], v1, s[98:99] offset:-1024
    global_load_dwordx4 a[192:195], v1, s[98:99] offset:0
    global_load_dwordx4 a[196:199], v1, s[98:99] offset:1024
    global_load_dwordx4 a[200:203], v1, s[98:99] offset:2048
    global_load_dwordx4 a[204:207], v1, s[98:99] offset:3072
    s_cmp_eq_u32 s3, 0
    s_cbranch_scc1 KB_t1
    s_cmp_eq_u32 s3, 1
    s_cbranch_scc1 KB_t2
    s_cmp_eq_u32 s3, 2
    s_cbranch_scc1 KB_t3
    s_branch KB_tret
KB_tret:
    s_waitcnt vmcnt(8)
    v_cmp_ne_u32 vcc, 0x01010101, v31
    s_cbranch_vccz KB_pl0_done
KB_pl0_loop:
    global_load_dword v31, v30, s[66:67] offset:128 sc1
    s_add_u32 s52, s52, 1
    s_waitcnt vmcnt(0)
    v_cmp_ne_u32 vcc, 0x01010101, v31
    s_cbranch_vccz KB_pl0_done
    s_cmp_lt_u32 s52, 131072
    s_cbranch_scc1 KB_pl0_loop
KB_pl0_done:
    global_load_dwordx4 v[32:35], v1, s[22:23] offset:-4096 sc1
    global_load_dwordx4 v[36:39], v1, s[22:23] offset:-3072 sc1
    global_load_dwordx4 v[40:43], v1, s[22:23] offset:-2048 sc1
    global_load_dwordx4 v[44:47], v1, s[22:23] offset:-1024 sc1
    global_load_dwordx4 v[48:51], v1, s[22:23] offset:0 sc1
    global_load_dwordx4 v[52:55], v1, s[22:23] offset:1024 sc1
    global_load_dwordx4 v[56:59], v1, s[22:23] offset:2048 sc1
    global_load_dwordx4 v[60:63], v1, s[22:23] offset:3072 sc1
    global_load_dwordx4 v[64:67], v7, s[22:23] offset:-4096 sc1
    global_load_dwordx4 v[68:71], v7, s[22:23] offset:-3072 sc1
    global_load_dwordx4 v[72:75], v7, s[22:23] offset:-2048 sc1
    global_load_dwordx4 v[76:79], v7, s[22:23] offset:-1024 sc1
    global_load_dwordx4 v[80:83], v7, s[22:23] offset:0 sc1
    global_load_dwordx4 v[84:87], v7, s[22:23] offset:1024 sc1
    global_load_dwordx4 v[88:91], v7, s[22:23] offset:2048 sc1
    global_load_dwordx4 v[92:95], v7, s[22:23] offset:3072 sc1
    v_min_u32 v30, 24, v30
    s_mov_b32 s53, 0x3f803f80
    v_mov_b32 v12, 0
    v_mov_b32 v13, 0
    s_waitcnt vmcnt(15)
    v_mfma_f32_32x32x16_bf16 v[112:127], v[144:147], v[32:35], 0
    global_load_dwordx4 a[208:211], v7, s[98:99] offset:-4096
    v_mfma_f32_32x32x16_bf16 v[96:111], v[208:211], v[32:35], v[96:111]
    s_waitcnt vmcnt(15)
    v_mfma_f32_32x32x16_bf16 v[112:127], v[148:151], v[36:39], v[112:127]
    global_load_dwordx4 a[212:215], v7, s[98:99] offset:-3072
    v_mfma_f32_32x32x16_bf16 v[96:111], v[212:215], v[36:39], v[96:111]
    s_waitcnt vmcnt(15)
    v_mfma_f32_32x32x16_bf16 v[112:127], v[152:155], v[40:43], v[112:127]
    global_load_dwordx4 a[216:219], v7, s[98:99] offset:-2048
    v_mfma_f32_32x32x16_bf16 v[96:111], v[216:219], v[40:43], v[96:111]
    s_branch KB_sk1
KB_t1:
    s_branch KB_tret
KB_sk1:
    s_waitcnt vmcnt(15)
    v_mfma_f32_32x32x16_bf16 v[112:127], v[156:159], v[44:47], v[112:127]
    global_load_dwordx4 a[220:223], v7, s[98:99] offset:-1024
    v_mfma_f32_32x32x16_bf16 v[96:111], v[220:223], v[44:47], v[96:111]
    s_waitcnt vmcnt(15)
    v_mfma_f32_32x32x16_bf16 v[112:127], v[160:163], v[48:51], v[112:127]
    global_load_dwordx4 a[16:19], v9, s[98:99] offset:-4096
    v_mfma_f32_32x32x16_bf16 v[96:111], a[48:51], v[48:51], v[96:111]
    s_waitcnt vmcnt(15)
    v_mfma_f32_32x32x16_bf16 v[112:127], v[164:167], v[52:55], v[112:127]
    global_load_dwordx4 a[20:23], v9, s[98:99] offset:-3072
    v_mfma_f32_32x32x16_bf16 v[96:111], a[52:55], v[52:55], v[96:111]
    s_waitcnt vmcnt(15)
    v_mfma_f32_32x32x16_bf16 v[112:127], v[168:171], v[56:59], v[112:127]
    global_load_dwordx4 a[24:27], v9, s[98:99] offset:-2048
    v_mfma_f32_32x32x16_bf16 v[96:111], a[56:59], v[56:59], v[96:111]
    s_waitcnt vmcnt(15)
    v_mfma_f32_32x32x16_bf16 v[112:127], v[172:175], v[60:63], v[112:127]
    global_load_dwordx4 a[28:31], v9, s[98:99] offset:-1024
    v_mfma_f32_32x32x16_bf16 v[96:111], a[60:63], v[60:63], v[96:111]
    s_waitcnt vmcnt(15)
    v_mfma_f32_32x32x16_bf16 v[112:127], v[176:179], v[64:67], v[112:127]
    global_load_dwordx4 a[32:35], v9, s[98:99] offset:0
    v_mfma_f32_32x32x16_bf16 v[96:111], a[224:227], v[64:67], v[96:111]
    s_waitcnt vmcnt(15)
    v_mfma_f32_32x32x16_bf16 v[112:127], v[180:183], v[68:71], v[112:127]
    global_load_dwordx4 a[36:39], v9, s[98:99] offset:1024
    s_waitcnt vmcnt(15)
    v_mfma_f32_32x32x16_bf16 v[112:127], v[184:187], v[72:75], v[112:127]
    s_waitcnt vmcnt(14)
    v_mfma_f32_32x32x16_bf16 v[112:127], v[188:191], v[76:79], v[112:127]
    s_waitcnt vmcnt(13)
    v_mfma_f32_32x32x16_bf16 v[112:127], v[192:195], v[80:83], v[112:127]
    s_waitcnt vmcnt(12)
    v_mfma_f32_32x32x16_bf16 v[112:127], v[196:199], v[84:87], v[112:127]
    s_waitcnt vmcnt(11)
    v_mfma_f32_32x32x16_bf16 v[112:127], v[200:203], v[88:91], v[112:127]
    s_waitcnt vmcnt(10)
    v_mfma_f32_32x32x16_bf16 v[112:127], v[204:207], v[92:95], v[112:127]
    v_mfma_f32_32x32x16_bf16 v[96:111], a[228:231], v[68:71], v[96:111]
    v_mfma_f32_32x32x16_bf16 v[96:111], a[232:235], v[72:75], v[96:111]
    ds_write_b128 v14, v[112:115] offset:0
    ds_write_b128 v14, v[116:119] offset:1024
    v_mfma_f32_32x32x16_bf16 v[96:111], a[236:239], v[76:79], v[96:111]
    ds_write_b128 v14, v[120:123] offset:2048
    ds_write_b128 v14, v[124:127] offset:3072
    v_mfma_f32_32x32x16_bf16 v[96:111], a[240:243], v[80:83], v[96:111]
    v_mfma_f32_32x32x16_bf16 v[96:111], a[244:247], v[84:87], v[96:111]
    s_waitcnt lgkmcnt(0)
    s_barrier
    ds_read_b128 v[32:35], v15 offset:0
    ds_read_b128 v[36:39], v15 offset:1024
    ds_read_b128 v[40:43], v15 offset:2048
    ds_read_b128 v[44:47], v15 offset:3072
    v_mfma_f32_32x32x16_bf16 v[96:111], a[248:251], v[88:91], v[96:111]
    v_mfma_f32_32x32x16_bf16 v[96:111], a[252:255], v[92:95], v[96:111]
    s_nop 7
    s_nop 2
    s_waitcnt lgkmcnt(3)
    v_add_f32 v96, v96, v32
    v_add_f32 v97, v97, v33
    v_add_f32 v98, v98, v34
    v_add_f32 v99, v99, v35
    s_waitcnt lgkmcnt(2)
    v_add_f32 v100, v100, v36
    v_add_f32 v101, v101, v37
    v_add_f32 v102, v102, v38
    v_add_f32 v103, v103, v39
    v_cvt_pk_bf16_f32 v48, v96, v97
    v_cvt_pk_bf16_f32 v49, v98, v99
    v_cvt_pk_bf16_f32 v50, v100, v101
    v_cvt_pk_bf16_f32 v51, v102, v103
    global_store_dwordx4 v26, v[48:51], s[54:55] offset:0
    s_waitcnt lgkmcnt(1)
    v_add_f32 v104, v104, v40
    v_add_f32 v105, v105, v41
    v_add_f32 v106, v106, v42
    v_add_f32 v107, v107, v43
    s_waitcnt lgkmcnt(0)
    v_add_f32 v108, v108, v44
    v_add_f32 v109, v109, v45
    v_add_f32 v110, v110, v46
    v_add_f32 v111, v111, v47
    v_cvt_pk_bf16_f32 v52, v104, v105
    v_cvt_pk_bf16_f32 v53, v106, v107
    v_cvt_pk_bf16_f32 v54, v108, v109
    v_cvt_pk_bf16_f32 v55, v110, v111
    global_store_dwordx4 v26, v[52:55], s[54:55] offset:1024
    v_dot2c_f32_bf16 v12, s53, v48
    v_dot2c_f32_bf16 v13, v48, v48
    v_dot2c_f32_bf16 v12, s53, v49
    v_dot2c_f32_bf16 v13, v49, v49
    v_dot2c_f32_bf16 v12, s53, v50
    v_dot2c_f32_bf16 v13, v50, v50
    v_dot2c_f32_bf16 v12, s53, v51
    v_dot2c_f32_bf16 v13, v51, v51
    v_dot2c_f32_bf16 v12, s53, v52
    v_dot2c_f32_bf16 v13, v52, v52
    v_dot2c_f32_bf16 v12, s53, v53
    v_dot2c_f32_bf16 v13, v53, v53
    v_dot2c_f32_bf16 v12, s53, v54
    v_dot2c_f32_bf16 v13, v54, v54
    v_dot2c_f32_bf16 v12, s53, v55
    v_dot2c_f32_bf16 v13, v55, v55
    s_nop 2
    v_mov_b32 v14, v12
    v_mov_b32 v15, v13
    s_nop 0
    v_permlane32_swap_b32 v14, v12
    v_permlane32_swap_b32 v15, v13
    s_mov_b32 exec_hi, 0
    v_add_f32 v12, v12, v14
    v_add_f32 v13, v13, v15
    global_store_dwordx2 v27, v[12:13], s[54:55]
    s_mov_b32 exec_hi, -1
    global_load_dwordx4 a[40:43], v9, s[98:99] offset:2048
    global_load_dwordx4 a[44:47], v9, s[98:99] offset:3072
    global_load_dwordx4 a[48:51], v8, s[98:99] offset:-4096
    global_load_dwordx4 a[52:55], v8, s[98:99] offset:-3072
    global_load_dwordx4 a[56:59], v8, s[98:99] offset:-2048
    global_load_dwordx4 a[60:63], v8, s[98:99] offset:-1024
    s_waitcnt vmcnt(6)
    s_cmp_eq_u32 s68, 0
    s_cbranch_scc1 KB_sg1_fence
    s_mov_b64 exec, 1
    global_store_byte v10, v11, s[66:67] offset:256
    s_mov_b64 exec, -1
KB_sg1_done:
    s_lshl_b32 s61, s3, 12
    s_add_u32 s29, s61, 12288
    s_add_u32 s30, s61, 32768
    s_add_u32 s31, s61, 49152
    s_cmp_eq_u32 s3, 3
    s_cselect_b32 s59, 28672, s61
    s_cselect_b32 s29, 32768, s29
    s_cmp_eq_u32 s3, 0
    s_cselect_b32 s30, 24576, s30
    s_add_u32 s48, s54, s59
    s_addc_u32 s49, s55, 0
    s_add_u32 s50, s54, s29
    s_addc_u32 s51, s55, 0
    s_add_u32 s56, s54, s30
    s_addc_u32 s57, s55, 0
    s_add_u32 s62, s54, s31
    s_addc_u32 s63, s55, 0
    s_mul_i32 s53, s4, 458752
    s_mul_i32 s58, s5, 3584
    s_add_u32 s53, s53, s58
    s_add_u32 s53, s53, 11534336
    s_add_u32 s40, s8, s53
    s_addc_u32 s41, s9, 0
    s_lshl_b32 s58, s15, 8
    s_add_u32 s53, s53, s58
    s_add_u32 s7, s53, 3072
    s_mul_i32 s53, s3, 768
    s_add_u32 s40, s40, s53
    s_addc_u32 s41, s41, 0
    s_lshl_b32 s53, s5, 10
    s_lshl_b32 s47, s4, 16
    s_add_u32 s46, s47, s53
    s_add_u32 s46, s46, s58
    s_add_u32 s46, s46, 28311552
    s_cmp_eq_u32 s14, 0
    s_cselect_b32 s7, s7, s46
    s_cselect_b32 s46, 7, 1
    s_add_u32 s44, s8, s7
    s_addc_u32 s45, s9, 0
    s_lshl_b32 s7, s3, 8
    s_add_u32 s53, s53, s7
    s_add_u32 s42, s54, s53
    s_addc_u32 s43, s55, 0
    s_add_u32 s53, s53, s47
    s_add_u32 s20, s8, s53
    s_addc_u32 s21, s9, 0
    s_add_u32 s22, s20, 7340032
    s_addc_u32 s23, s21, 0
    v_lshrrev_b32 v21, 2, v5
    v_lshlrev_b32 v12, 6, v2
    v_lshl_add_u32 v12, v6, 4, v12
    v_mul_u32_u24 v22, s46, v21
    v_lshl_add_u32 v22, v22, 13, v12
    v_lshl_add_u32 v23, v21, 13, v12
    v_lshrrev_b32 v3, 4, v5
    v_mul_u32_u24 v3, 8192, v3
    v_add_u32 v3, v3, v12
    v_mul_u32_u24 v21, 7168, v21
    v_add_u32 v3, v3, v21
    v_lshl_add_u32 v12, v21, 3, v12
    s_lshl_b32 s53, s3, 11
    s_add_u32 s53, s53, 65536
    v_add_u32 v13, s53, v1
    v_add_u32 v14, 65536, v1
    s_lshl_b32 s53, s14, 14
    v_add_u32 v15, s53, v14
    v_add_u32 v18, s60, v1
    v_mul_u32_u24 v19, 1792, v2
    v_lshl_add_u32 v19, v5, 3, v19
    v_lshlrev_b32 v20, 2, v5
    v_add_u32 v20, 32256, v20
    s_lshl_b32 s53, s5, 2
    s_or_b32 s53, s53, s3
    s_cmp_eq_u32 s53, 0
    s_cselect_b32 s46, -1, 0
    s_mov_b32 s47, 0
    s_mov_b32 s58, 0x3f3504f3
    s_mov_b32 s52, 0
    s_cmp_eq_u32 s68, 0
    s_cbranch_scc1 KB_pl1_fence
    global_load_dword v31, v30, s[66:67] offset:256 sc1
    global_load_dwordx4 v[32:35], v8, s[96:97] sc1
    global_load_dwordx4 v[36:39], v8, s[98:99] sc1
    global_load_dwordx4 a[224:227], v1, s[32:33] offset:-4096
    global_load_dwordx4 a[228:231], v1, s[32:33] offset:-3072
    global_load_dwordx4 a[232:235], v1, s[32:33] offset:-2048
    s_waitcnt vmcnt(5)
    v_cmp_ne_u32 vcc, 0x01010101, v31
    s_cbranch_vccz KB_pl1_done
KB_pl1_loop:
    global_load_dword v31, v30, s[66:67] offset:256 sc1
    s_add_u32 s52, s52, 1
    s_waitcnt vmcnt(0)
    v_cmp_ne_u32 vcc, 0x01010101, v31
    s_cbranch_vccz KB_pl1_done
    s_cmp_lt_u32 s52, 131072
    s_cbranch_scc1 KB_pl1_loop
KB_pl1_done:
    s_mov_b32 m0, s59
    s_nop 0
    global_load_lds_dwordx4 v1, s[48:49] offset:0 sc1
    global_load_lds_dwordx4 v1, s[48:49] offset:1024 sc1
    global_load_lds_dwordx4 v1, s[48:49] offset:2048 sc1
    global_load_lds_dwordx4 v1, s[48:49] offset:3072 sc1
    s_mov_b32 m0, s29
    s_nop 0
    global_load_lds_dwordx4 v1, s[50:51] offset:0 sc1
    global_load_lds_dwordx4 v1, s[50:51] offset:1024 sc1
    global_load_lds_dwordx4 v1, s[50:51] offset:2048 sc1
    global_load_lds_dwordx4 v1, s[50:51] offset:3072 sc1
    s_waitcnt vmcnt(4)
    s_barrier
    ds_read_b128 v[144:147], v1 offset:0
    ds_read_b128 v[148:151], v1 offset:1024
    ds_read_b128 v[152:155], v1 offset:2048
    ds_read_b128 v[156:159], v1 offset:3072
    ds_read_b64 v[48:49], v19 offset:28672
    ds_read_b64 v[50:51], v19 offset:28928
    ds_read_b64 v[52:53], v19 offset:29184
    ds_read_b64 v[54:55], v19 offset:29440
    ds_read_b64 v[56:57], v19 offset:29696
    ds_read_b64 v[58:59], v19 offset:29952
    ds_read_b64 v[60:61], v19 offset:30208
    s_waitcnt lgkmcnt(10)
    v_mfma_f32_32x32x16_bf16 v[80:95], a[64:67], v[144:147], 0
    ds_read_b128 v[160:163], v1 offset:4096
    s_waitcnt lgkmcnt(10)
    v_mfma_f32_32x32x16_bf16 v[80:95], a[68:71], v[148:151], v[80:95]
    ds_read_b128 v[164:167], v1 offset:5120
    s_mov_b32 m0, s30
    s_nop 0
    global_load_lds_dwordx4 v1, s[56:57] offset:0 sc1
    s_waitcnt lgkmcnt(9)
    v_mfma_f32_32x32x16_bf16 v[80:95], a[72:75], v[152:155], v[80:95]
    ds_read_b128 v[168:171], v1 offset:6144
    global_load_lds_dwordx4 v1, s[56:57] offset:1024 sc1
    v_mfma_f32_32x32x16_bf16 v[80:95], a[76:79], v[156:159], v[80:95]
    ds_read_b128 v[172:175], v1 offset:7168
    global_load_lds_dwordx4 v1, s[56:57] offset:2048 sc1
    s_waitcnt lgkmcnt(4)
    v_add_f32 v48, v48, v50
    v_add_f32 v49, v49, v51
    v_add_f32 v52, v52, v54
    s_waitcnt lgkmcnt(2)
    v_mfma_f32_32x32x16_bf16 v[80:95], a[80:83], v[160:163], v[80:95]
    ds_read_b128 v[176:179], v1 offset:8192
    global_load_lds_dwordx4 v1, s[56:57] offset:3072 sc1
    v_add_f32 v53, v53, v55
    v_add_f32 v56, v56, v58
    v_mfma_f32_32x32x16_bf16 v[80:95], a[84:87], v[164:167], v[80:95]
    ds_read_b128 v[180:183], v1 offset:9216
    s_mov_b32 m0, s31
    s_nop 0
    global_load_lds_dwordx4 v1, s[62:63] offset:0 sc1
    v_add_f32 v57, v57, v59
    s_waitcnt lgkmcnt(2)
    v_mfma_f32_32x32x16_bf16 v[80:95], a[88:91], v[168:171], v[80:95]
    ds_read_b128 v[184:187], v1 offset:10240
    global_load_lds_dwordx4 v1, s[62:63] offset:1024 sc1
    v_add_f32 v48, v48, v52
    v_add_f32 v49, v49, v53
    v_mfma_f32_32x32x16_bf16 v[80:95], a[92:95], v[172:175], v[80:95]
    ds_read_b128 v[188:191], v1 offset:11264
    global_load_lds_dwordx4 v1, s[62:63] offset:2048 sc1
    v_add_f32 v56, v56, v60
    v_add_f32 v57, v57, v61
    v_add_f32 v48, v48, v56
    s_waitcnt lgkmcnt(2)
    v_mfma_f32_32x32x16_bf16 v[80:95], a[96:99], v[176:179], v[80:95]
    s_waitcnt vmcnt(7)
    s_barrier
    ds_read_b128 v[192:195], v1 offset:12288
    global_load_lds_dwordx4 v1, s[62:63] offset:3072 sc1
    v_add_f32 v49, v49, v57
    v_mfma_f32_32x32x16_bf16 v[80:95], a[100:103], v[180:183], v[80:95]
    ds_read_b128 v[196:199], v1 offset:13312
    ds_read_b64 v[64:65], v19 offset:32768
    v_mov_b32 v50, v48
    v_mov_b32 v51, v49
    s_nop 0
    s_waitcnt lgkmcnt(3)
    v_mfma_f32_32x32x16_bf16 v[80:95], a[104:107], v[184:187], v[80:95]
    ds_read_b128 v[200:203], v1 offset:14336
    global_load_dwordx4 a[236:239], v1, s[32:33] offset:-1024
    ds_read_b64 v[66:67], v19 offset:33024
    v_mfma_f32_32x32x16_bf16 v[80:95], a[108:111], v[188:191], v[80:95]
    ds_read_b128 v[204:207], v1 offset:15360
    ds_read_b64 v[68:69], v19 offset:33280
    v_permlane32_swap_b32 v50, v48
    v_permlane32_swap_b32 v51, v49
    s_waitcnt lgkmcnt(5)
    v_mfma_f32_32x32x16_bf16 v[80:95], a[112:115], v[192:195], v[80:95]
    ds_read_b128 v[208:211], v1 offset:16384
    global_load_dwordx4 a[240:243], v1, s[32:33] offset:0
    ds_read_b64 v[70:71], v19 offset:33536
    v_mfma_f32_32x32x16_bf16 v[80:95], a[116:119], v[196:199], v[80:95]
    ds_read_b128 v[212:215], v1 offset:17408
    ds_read_b64 v[72:73], v19 offset:33792
    s_nop 0
    v_add_f32 v48, v48, v50
    v_add_f32 v49, v49, v51
    s_waitcnt lgkmcnt(5)
    v_mfma_f32_32x32x16_bf16 v[80:95], a[120:123], v[200:203], v[80:95]
    ds_read_b128 v[216:219], v1 offset:18432
    global_load_dwordx4 a[244:247], v1, s[32:33] offset:1024
    ds_read_b64 v[74:75], v19 offset:34048
    v_mfma_f32_32x32x16_bf16 v[80:95], a[124:127], v[204:207], v[80:95]
    ds_read_b128 v[220:223], v1 offset:19456
    ds_read_b64 v[76:77], v19 offset:34304
    v_mul_f32 v48, 0xbb124925, v48
    v_mul_f32 v49, 0x3b124925, v49
    v_fma_f32 v49, -v48, v48, v49
    s_waitcnt lgkmcnt(5)
    v_mfma_f32_32x32x16_bf16 v[80:95], a[128:131], v[208:211], v[80:95]
    ds_read_b128 v[224:227], v1 offset:20480
    global_load_dwordx4 a[248:251], v1, s[32:33] offset:2048
    v_cvt_pk_bf16_f32 v41, v48, v48
    v_max_f32 v49, 0, v49
    v_mfma_f32_32x32x16_bf16 v[80:95], a[132:135], v[212:215], v[80:95]
    ds_read_b128 v[228:231], v1 offset:21504
    v_lshlrev_b32 v52, 16, v41
    v_add_f32 v49, 0x3727c5ac, v49
    v_sub_f32 v51, v48, v52
    v_rsq_f32 v16, v49
    s_waitcnt lgkmcnt(3)
    v_mfma_f32_32x32x16_bf16 v[80:95], a[136:139], v[216:219], v[80:95]
    ds_read_b128 v[232:235], v1 offset:22528
    global_load_dwordx4 a[252:255], v1, s[32:33] offset:3072
    v_cvt_pk_bf16_f32 v40, v52, v51
    v_mul_f32 v49, v49, v16
    v_mfma_f32_32x32x16_bf16 v[80:95], a[140:143], v[220:223], v[80:95]
    ds_read_b128 v[236:239], v1 offset:23552
    v_mov_b32 v42, v40
    v_mul_f32 v16, 0x3fb8aa3b, v16
    v_cvt_pk_bf16_f32 v41, v52, v49
    v_and_b32 v50, 0xffff0000, v41
    v_sub_f32 v51, v49, v50
    s_waitcnt lgkmcnt(2)
    v_mfma_f32_32x32x16_bf16 v[80:95], a[144:147], v[224:227], v[80:95]
    s_waitcnt vmcnt(9)
    s_barrier
    ds_read_b128 v[240:243], v1 offset:24576
    s_add_u32 m0, s60, 0
    s_nop 0
    global_load_lds_dwordx4 v1, s[70:71] offset:0
    v_mfma_f32_32x32x16_bf16 v[80:95], a[148:151], v[228:231], v[80:95]
    ds_read_b128 v[244:247], v1 offset:25600
    v_cvt_pk_bf16_f32 v43, v52, v51
    s_nop 1
    s_mov_b64 exec, s[46:47]
    global_store_dword v20, v16, s[54:55] offset:0
    s_mov_b64 exec, -1
    s_waitcnt lgkmcnt(2)
    v_mfma_f32_32x32x16_bf16 v[80:95], a[152:155], v[232:235], v[80:95]
    ds_read_b128 v[248:251], v1 offset:26624
    global_load_lds_dwordx4 v1, s[70:71] offset:1024
    v_mfma_f32_32x32x16_bf16 v[80:95], a[156:159], v[236:239], v[80:95]
    ds_read_b128 v[252:255], v1 offset:27648
    v_add_f32 v64, v64, v66
    v_add_f32 v65, v65, v67
    v_add_f32 v68, v68, v70
    v_add_f32 v69, v69, v71
    v_add_f32 v72, v72, v74
    v_add_f32 v73, v73, v75
    s_waitcnt lgkmcnt(2)
    v_mfma_f32_32x32x16_bf16 v[80:95], a[160:163], v[240:243], v[80:95]
    global_load_lds_dwordx4 v1, s[70:71] offset:2048
    v_add_f32 v64, v64, v68
    v_add_f32 v65, v65, v69
    v_add_f32 v72, v72, v76
    v_add_f32 v73, v73, v77
    v_mfma_f32_32x32x16_bf16 v[80:95], a[164:167], v[244:247], v[80:95]
    v_add_f32 v64, v64, v72
    v_add_f32 v65, v65, v73
    v_mov_b32 v66, v64
    v_mov_b32 v67, v65
    s_nop 0
    v_permlane32_swap_b32 v66, v64
    s_waitcnt lgkmcnt(0)
    v_mfma_f32_32x32x16_bf16 v[80:95], a[168:171], v[248:251], v[80:95]
    global_load_lds_dwordx4 v1, s[70:71] offset:3072
    v_permlane32_swap_b32 v67, v65
    s_nop 0
    v_add_f32 v64, v64, v66
    v_add_f32 v65, v65, v67
    v_mul_f32 v64, 0xbb124925, v64
    v_mfma_f32_32x32x16_bf16 v[80:95], a[172:175], v[252:255], v[80:95]
    v_mul_f32 v65, 0x3b124925, v65
    v_fma_f32 v65, -v64, v64, v65
    v_cvt_pk_bf16_f32 v45, v64, v64
    v_max_f32 v65, 0, v65
    v_lshlrev_b32 v68, 16, v45
    v_add_f32 v65, 0x3727c5ac, v65
    v_mfma_f32_32x32x16_bf16 v[80:95], v[32:35], v[40:43], v[80:95]
    s_add_u32 m0, s60, 4096
    s_add_u32 s70, s70, 4096
    s_addc_u32 s71, s71, 0
    global_load_lds_dwordx4 v1, s[70:71] offset:0
    v_sub_f32 v67, v64, v68
    v_rsq_f32 v17, v65
    v_mfma_f32_32x32x16_bf16 v[96:111], a[176:179], v[144:147], 0
    ds_read_b128 v[144:147], v1 offset:36864
    v_cvt_pk_bf16_f32 v44, v68, v67
    v_mul_f32 v65, v65, v17
    v_mov_b32 v46, v44
    v_mul_f32 v17, 0x3fb8aa3b, v17
    v_cvt_pk_bf16_f32 v45, v68, v65
    v_mfma_f32_32x32x16_bf16 v[96:111], a[180:183], v[148:151], v[96:111]
    global_load_lds_dwordx4 v1, s[70:71] offset:1024
    ds_read_b128 v[148:151], v1 offset:37888
    v_and_b32 v66, 0xffff0000, v45
    v_sub_f32 v67, v65, v66
    v_cvt_pk_bf16_f32 v47, v68, v67
    v_mfma_f32_32x32x16_bf16 v[96:111], a[184:187], v[152:155], v[96:111]
    ds_read_b128 v[152:155], v1 offset:38912
    s_nop 1
    s_mov_b64 exec, s[46:47]
    global_store_dword v20, v17, s[54:55] offset:128
    s_mov_b64 exec, -1
    v_mfma_f32_32x32x16_bf16 v[96:111], a[188:191], v[156:159], v[96:111]
    global_load_lds_dwordx4 v1, s[70:71] offset:2048
    ds_read_b128 v[156:159], v1 offset:39936
    v_fma_f32 v24, v80, v16, -0.5
    v_fma_f32 v25, v81, v16, -0.5
    v_fma_f32 v26, v82, v16, -0.5
    v_mfma_f32_32x32x16_bf16 v[96:111], a[192:195], v[160:163], v[96:111]
    ds_read_b128 v[160:163], v1 offset:40960
    v_fma_f32 v27, v83, v16, -0.5
    v_exp_f32 v24, v24
    v_exp_f32 v25, v25
    v_mfma_f32_32x32x16_bf16 v[96:111], a[196:199], v[164:167], v[96:111]
    global_load_lds_dwordx4 v1, s[70:71] offset:3072
    ds_read_b128 v[164:167], v1 offset:41984
    v_exp_f32 v26, v26
    v_exp_f32 v27, v27
    v_mfma_f32_32x32x16_bf16 v[96:111], a[200:203], v[168:171], v[96:111]
    ds_read_b128 v[168:171], v1 offset:43008
    v_add_f32 v24, s58, v24
    v_add_f32 v25, s58, v25
    v_add_f32 v26, s58, v26
    v_add_f32 v27, s58, v27
    v_fma_f32 v24, -v24, v24, -0.5
    v_mfma_f32_32x32x16_bf16 v[96:111], a[204:207], v[172:175], v[96:111]
    s_add_u32 m0, s60, 8192
    s_add_u32 s70, s70, 102400
    s_addc_u32 s71, s71, 0
    global_load_lds_dwordx4 v1, s[70:71] offset:0
    ds_read_b128 v[172:175], v1 offset:44032
    v_mfma_f32_32x32x16_bf16 v[96:111], a[208:211], v[176:179], v[96:111]
    ds_read_b128 v[176:179], v1 offset:45056
    v_fma_f32 v25, -v25, v25, -0.5
    v_fma_f32 v26, -v26, v26, -0.5
    v_fma_f32 v27, -v27, v27, -0.5
    v_rcp_f32 v24, v24
    v_mfma_f32_32x32x16_bf16 v[96:111], a[212:215], v[180:183], v[96:111]
    global_load_lds_dwordx4 v1, s[70:71] offset:1024
    ds_read_b128 v[180:183], v1 offset:46080
    v_rcp_f32 v25, v25
    v_rcp_f32 v26, v26
    v_mfma_f32_32x32x16_bf16 v[96:111], a[216:219], v[184:187], v[96:111]
    ds_read_b128 v[184:187], v1 offset:47104
    v_rcp_f32 v27, v27
    v_fmac_f32 v80, v80, v24
    v_fmac_f32 v81, v81, v25
    v_fmac_f32 v82, v82, v26
    v_mfma_f32_32x32x16_bf16 v[96:111], a[220:223], v[188:191], v[96:111]
    global_load_lds_dwordx4 v1, s[70:71] offset:2048
    s_waitcnt vmcnt(18)
    s_barrier
    ds_read_b128 v[188:191], v1 offset:48128
    v_fmac_f32 v83, v83, v27
    v_mfma_f32_32x32x16_bf16 v[96:111], a[0:3], v[192:195], v[96:111]
    ds_read_b128 v[192:195], v1 offset:49152
    v_cvt_pk_bf16_f32 v80, v80, v81
    v_cvt_pk_bf16_f32 v81, v82, v83
    v_fma_f32 v28, v84, v16, -0.5
    v_fma_f32 v29, v85, v16, -0.5
    v_mfma_f32_32x32x16_bf16 v[96:111], a[4:7], v[196:199], v[96:111]
    global_load_lds_dwordx4 v1, s[70:71] offset:3072
    ds_read_b128 v[196:199], v1 offset:50176
    s_cmp_eq_u32 s68, 0
    s_cbranch_scc1 KB_hd_fence
    s_mov_b64 exec, 1
    global_store_byte v10, v11, s[66:67] offset:896
    s_mov_b64 exec, -1
KB_hd_done:
    v_mfma_f32_32x32x16_bf16 v[96:111], a[8:11], v[200:203], v[96:111]
    ds_read_b128 v[200:203], v1 offset:51200
    v_fma_f32 v30, v86, v16, -0.5
    v_fma_f32 v31, v87, v16, -0.5
    v_exp_f32 v28, v28
    v_mfma_f32_32x32x16_bf16 v[96:111], a[12:15], v[204:207], v[96:111]
    s_add_u32 m0, s60, 12288
    s_add_u32 s70, s70, 4096
    s_addc_u32 s71, s71, 0
    global_load_lds_dwordx4 v1, s[70:71] offset:0
    ds_read_b128 v[204:207], v1 offset:52224
    v_mfma_f32_32x32x16_bf16 v[96:111], a[16:19], v[208:211], v[96:111]
    ds_read_b128 v[208:211], v1 offset:53248
    v_exp_f32 v29, v29
    v_exp_f32 v30, v30
    v_exp_f32 v31, v31
    v_mfma_f32_32x32x16_bf16 v[96:111], a[20:23], v[212:215], v[96:111]
    global_load_lds_dwordx4 v1, s[70:71] offset:1024
    ds_read_b128 v[212:215], v1 offset:54272
    v_add_f32 v28, s58, v28
    v_add_f32 v29, s58, v29
    v_mfma_f32_32x32x16_bf16 v[96:111], a[24:27], v[216:219], v[96:111]
    ds_read_b128 v[216:219], v1 offset:55296
    v_add_f32 v30, s58, v30
    v_add_f32 v31, s58, v31
    v_fma_f32 v28, -v28, v28, -0.5
    v_fma_f32 v29, -v29, v29, -0.5
    v_fma_f32 v30, -v30, v30, -0.5
    v_mfma_f32_32x32x16_bf16 v[96:111], a[28:31], v[220:223], v[96:111]
    global_load_lds_dwordx4 v1, s[70:71] offset:2048
    ds_read_b128 v[220:223], v1 offset:56320
    v_fma_f32 v31, -v31, v31, -0.5
    v_rcp_f32 v28, v28
    v_mfma_f32_32x32x16_bf16 v[96:111], a[32:35], v[224:227], v[96:111]
    ds_read_b128 v[224:227], v1 offset:57344
    v_rcp_f32 v29, v29
    v_rcp_f32 v30, v30
    v_rcp_f32 v31, v31
    v_mfma_f32_32x32x16_bf16 v[96:111], a[36:39], v[228:231], v[96:111]
    global_load_lds_dwordx4 v1, s[70:71] offset:3072
    ds_read_b128 v[228:231], v1 offset:58368
    v_fmac_f32 v84, v84, v28
    v_fmac_f32 v85, v85, v29
    v_fmac_f32 v86, v86, v30
    v_mfma_f32_32x32x16_bf16 v[96:111], a[40:43], v[232:235], v[96:111]
    ds_read_b128 v[232:235], v1 offset:59392
    v_fmac_f32 v87, v87, v31
    v_cvt_pk_bf16_f32 v82, v84, v85
    v_cvt_pk_bf16_f32 v83, v86, v87
    v_fma_f32 v24, v88, v16, -0.5
    v_mfma_f32_32x32x16_bf16 v[96:111], a[44:47], v[236:239], v[96:111]
    ds_read_b128 v[236:239], v1 offset:60416
    v_fma_f32 v25, v89, v16, -0.5
    v_fma_f32 v26, v90, v16, -0.5
    v_fma_f32 v27, v91, v16, -0.5
    v_exp_f32 v24, v24
    v_mfma_f32_32x32x16_bf16 v[96:111], a[48:51], v[240:243], v[96:111]
    ds_read_b128 v[240:243], v1 offset:61440
    v_exp_f32 v25, v25
    v_exp_f32 v26, v26
    v_exp_f32 v27, v27
    v_mfma_f32_32x32x16_bf16 v[96:111], a[52:55], v[244:247], v[96:111]
    ds_read_b128 v[244:247], v1 offset:62464
    v_add_f32 v24, s58, v24
    v_add_f32 v25, s58, v25
    v_add_f32 v26, s58, v26
    v_add_f32 v27, s58, v27
    v_fma_f32 v24, -v24, v24, -0.5
    v_mfma_f32_32x32x16_bf16 v[96:111], a[56:59], v[248:251], v[96:111]
    ds_read_b128 v[248:251], v1 offset:63488
    v_fma_f32 v25, -v25, v25, -0.5
    v_fma_f32 v26, -v26, v26, -0.5
    v_fma_f32 v27, -v27, v27, -0.5
    v_rcp_f32 v24, v24
    v_mfma_f32_32x32x16_bf16 v[96:111], a[60:63], v[252:255], v[96:111]
    ds_read_b128 v[252:255], v1 offset:64512
    v_rcp_f32 v25, v25
    v_rcp_f32 v26, v26
    v_rcp_f32 v27, v27
    v_mfma_f32_32x32x16_bf16 v[96:111], v[36:39], v[40:43], v[96:111]
    v_fmac_f32 v88, v88, v24
    v_fmac_f32 v89, v89, v25
    v_fmac_f32 v90, v90, v26
    v_fmac_f32 v91, v91, v27
    v_cvt_pk_bf16_f32 v84, v88, v89
    v_cvt_pk_bf16_f32 v85, v90, v91
    s_waitcnt lgkmcnt(15)
    v_mfma_f32_32x32x16_bf16 v[112:127], a[176:179], v[144:147], 0
    global_load_dwordx4 a[176:179], v7, s[34:35] offset:-4096
    v_fma_f32 v28, v92, v16, -0.5
    v_fma_f32 v29, v93, v16, -0.5
    v_fma_f32 v30, v94, v16, -0.5
    v_fma_f32 v31, v95, v16, -0.5
    v_mfma_f32_32x32x16_bf16 v[112:127], a[180:183], v[148:151], v[112:127]
    v_exp_f32 v28, v28
    v_exp_f32 v29, v29
    v_exp_f32 v30, v30
    v_exp_f32 v31, v31
    v_mfma_f32_32x32x16_bf16 v[112:127], a[184:187], v[152:155], v[112:127]
    global_load_dwordx4 a[180:183], v7, s[34:35] offset:-3072
    v_add_f32 v28, s58, v28
    v_add_f32 v29, s58, v29
    v_add_f32 v30, s58, v30
    v_add_f32 v31, s58, v31
    v_mfma_f32_32x32x16_bf16 v[112:127], a[188:191], v[156:159], v[112:127]
    v_fma_f32 v28, -v28, v28, -0.5
    v_fma_f32 v29, -v29, v29, -0.5
    v_fma_f32 v30, -v30, v30, -0.5
    v_fma_f32 v31, -v31, v31, -0.5
    v_rcp_f32 v28, v28
    v_mfma_f32_32x32x16_bf16 v[112:127], a[192:195], v[160:163], v[112:127]
    v_rcp_f32 v29, v29
    v_rcp_f32 v30, v30
    v_rcp_f32 v31, v31
    v_mfma_f32_32x32x16_bf16 v[112:127], a[196:199], v[164:167], v[112:127]
    global_load_dwordx4 a[184:187], v7, s[34:35] offset:-2048
    v_fmac_f32 v92, v92, v28
    v_fmac_f32 v93, v93, v29
    v_fmac_f32 v94, v94, v30
    v_fmac_f32 v95, v95, v31
    v_cvt_pk_bf16_f32 v86, v92, v93
    v_cvt_pk_bf16_f32 v87, v94, v95
    v_mfma_f32_32x32x16_bf16 v[112:127], a[200:203], v[168:171], v[112:127]
    ds_write_b128 v13, v[80:83] offset:0
    ds_write_b128 v13, v[84:87] offset:1024
    v_mfma_f32_32x32x16_bf16 v[112:127], a[204:207], v[172:175], v[112:127]
    global_load_dwordx4 a[188:191], v7, s[34:35] offset:-1024
    v_fma_f32 v24, v96, v16, -0.5
    v_fma_f32 v25, v97, v16, -0.5
    v_fma_f32 v26, v98, v16, -0.5
    v_mfma_f32_32x32x16_bf16 v[112:127], a[208:211], v[176:179], v[112:127]
    v_fma_f32 v27, v99, v16, -0.5
    v_exp_f32 v24, v24
    v_exp_f32 v25, v25
    v_exp_f32 v26, v26
    v_mfma_f32_32x32x16_bf16 v[112:127], a[212:215], v[180:183], v[112:127]
    v_exp_f32 v27, v27
    v_add_f32 v24, s58, v24
    v_add_f32 v25, s58, v25
    v_add_f32 v26, s58, v26
    v_add_f32 v27, s58, v27
    v_mfma_f32_32x32x16_bf16 v[112:127], a[216:219], v[184:187], v[112:127]
    global_load_dwordx4 a[192:195], v7, s[34:35] offset:0
    v_fma_f32 v24, -v24, v24, -0.5
    v_fma_f32 v25, -v25, v25, -0.5
    v_fma_f32 v26, -v26, v26, -0.5
    v_fma_f32 v27, -v27, v27, -0.5
    v_mfma_f32_32x32x16_bf16 v[112:127], a[220:223], v[188:191], v[112:127]
    v_rcp_f32 v24, v24
    v_rcp_f32 v25, v25
    v_rcp_f32 v26, v26
    v_rcp_f32 v27, v27
    s_waitcnt lgkmcnt(14)
    v_mfma_f32_32x32x16_bf16 v[112:127], a[0:3], v[192:195], v[112:127]
    global_load_dwordx4 a[196:199], v7, s[34:35] offset:1024
    v_fmac_f32 v96, v96, v24
    v_fmac_f32 v97, v97, v25
    v_fmac_f32 v98, v98, v26
    v_mfma_f32_32x32x16_bf16 v[112:127], a[4:7], v[196:199], v[112:127]
    s_branch KB_sk2
KB_t2:
    s_branch KB_tret
KB_sk2:
    v_fmac_f32 v99, v99, v27
    v_cvt_pk_bf16_f32 v96, v96, v97
    v_cvt_pk_bf16_f32 v97, v98, v99
    v_fma_f32 v28, v100, v16, -0.5
    v_fma_f32 v29, v101, v16, -0.5
    v_fma_f32 v30, v102, v16, -0.5
    v_mfma_f32_32x32x16_bf16 v[112:127], a[8:11], v[200:203], v[112:127]
    v_fma_f32 v31, v103, v16, -0.5
    v_exp_f32 v28, v28
    v_exp_f32 v29, v29
    v_exp_f32 v30, v30
    v_mfma_f32_32x32x16_bf16 v[112:127], a[12:15], v[204:207], v[112:127]
    global_load_dwordx4 a[200:203], v7, s[34:35] offset:2048
    v_exp_f32 v31, v31
    v_add_f32 v28, s58, v28
    v_add_f32 v29, s58, v29
    v_add_f32 v30, s58, v30
    s_waitcnt lgkmcnt(10)
    v_mfma_f32_32x32x16_bf16 v[112:127], a[16:19], v[208:211], v[112:127]
    v_add_f32 v31, s58, v31
    v_fma_f32 v28, -v28, v28, -0.5
    v_fma_f32 v29, -v29, v29, -0.5
    v_fma_f32 v30, -v30, v30, -0.5
    v_fma_f32 v31, -v31, v31, -0.5
    v_mfma_f32_32x32x16_bf16 v[112:127], a[20:23], v[212:215], v[112:127]
    global_load_dwordx4 a[204:207], v7, s[34:35] offset:3072
    v_rcp_f32 v28, v28
    v_rcp_f32 v29, v29
    v_rcp_f32 v30, v30
    v_mfma_f32_32x32x16_bf16 v[112:127], a[24:27], v[216:219], v[112:127]
    v_rcp_f32 v31, v31
    v_fmac_f32 v100, v100, v28
    v_fmac_f32 v101, v101, v29
    v_fmac_f32 v102, v102, v30
    v_fmac_f32 v103, v103, v31
    v_mfma_f32_32x32x16_bf16 v[112:127], a[28:31], v[220:223], v[112:127]
    v_cvt_pk_bf16_f32 v98, v100, v101
    v_cvt_pk_bf16_f32 v99, v102, v103
    v_fma_f32 v24, v104, v16, -0.5
    v_fma_f32 v25, v105, v16, -0.5
    v_fma_f32 v26, v106, v16, -0.5
    s_waitcnt lgkmcnt(6)
    v_mfma_f32_32x32x16_bf16 v[112:127], a[32:35], v[224:227], v[112:127]
    global_load_dwordx4 a[208:211], v1, s[36:37] offset:-4096
    v_fma_f32 v27, v107, v16, -0.5
    v_exp_f32 v24, v24
    v_exp_f32 v25, v25
    v_mfma_f32_32x32x16_bf16 v[112:127], a[36:39], v[228:231], v[112:127]
    v_exp_f32 v26, v26
    v_exp_f32 v27, v27
    v_add_f32 v24, s58, v24
    v_add_f32 v25, s58, v25
    v_mfma_f32_32x32x16_bf16 v[112:127], a[40:43], v[232:235], v[112:127]
    global_load_dwordx4 a[212:215], v1, s[36:37] offset:-3072
    v_add_f32 v26, s58, v26
    v_add_f32 v27, s58, v27
    v_fma_f32 v24, -v24, v24, -0.5
    v_fma_f32 v25, -v25, v25, -0.5
    v_fma_f32 v26, -v26, v26, -0.5
    v_mfma_f32_32x32x16_bf16 v[112:127], a[44:47], v[236:239], v[112:127]
    v_fma_f32 v27, -v27, v27, -0.5
    v_rcp_f32 v24, v24
    v_rcp_f32 v25, v25
    v_rcp_f32 v26, v26
    s_waitcnt lgkmcnt(2)
    v_mfma_f32_32x32x16_bf16 v[112:127], a[48:51], v[240:243], v[112:127]
    v_rcp_f32 v27, v27
    v_fmac_f32 v104, v104, v24
    v_fmac_f32 v105, v105, v25
    v_fmac_f32 v106, v106, v26
    v_mfma_f32_32x32x16_bf16 v[112:127], a[52:55], v[244:247], v[112:127]
    global_load_dwordx4 a[216:219], v1, s[36:37] offset:-2048
    v_fmac_f32 v107, v107, v27
    v_cvt_pk_bf16_f32 v100, v104, v105
    v_cvt_pk_bf16_f32 v101, v106, v107
    v_fma_f32 v28, v108, v16, -0.5
    v_fma_f32 v29, v109, v16, -0.5
    v_mfma_f32_32x32x16_bf16 v[112:127], a[56:59], v[248:251], v[112:127]
    v_fma_f32 v30, v110, v16, -0.5
    v_fma_f32 v31, v111, v16, -0.5
    v_exp_f32 v28, v28
    v_exp_f32 v29, v29
    v_mfma_f32_32x32x16_bf16 v[112:127], a[60:63], v[252:255], v[112:127]
    global_load_dwordx4 a[220:223], v1, s[36:37] offset:-1024
    v_exp_f32 v30, v30
    v_exp_f32 v31, v31
    v_add_f32 v28, s58, v28
    v_add_f32 v29, s58, v29
    v_mfma_f32_32x32x16_bf16 v[112:127], v[36:39], v[44:47], v[112:127]
    v_add_f32 v30, s58, v30
    v_add_f32 v31, s58, v31
    v_fma_f32 v28, -v28, v28, -0.5
    v_fma_f32 v29, -v29, v29, -0.5
    v_fma_f32 v30, -v30, v30, -0.5
    v_fma_f32 v31, -v31, v31, -0.5
    v_mfma_f32_32x32x16_bf16 v[128:143], a[64:67], v[144:147], 0
    v_rcp_f32 v28, v28
    v_rcp_f32 v29, v29
    v_rcp_f32 v30, v30
    v_mfma_f32_32x32x16_bf16 v[128:143], a[68:71], v[148:151], v[128:143]
    global_load_dwordx4 a[0:3], v1, s[36:37] offset:0
    v_rcp_f32 v31, v31
    v_fmac_f32 v108, v108, v28
    v_fmac_f32 v109, v109, v29
    v_fmac_f32 v110, v110, v30
    v_fmac_f32 v111, v111, v31
    v_mfma_f32_32x32x16_bf16 v[128:143], a[72:75], v[152:155], v[128:143]
    v_cvt_pk_bf16_f32 v102, v108, v109
    v_cvt_pk_bf16_f32 v103, v110, v111
    ds_write_b128 v13, v[96:99] offset:8192
    v_mfma_f32_32x32x16_bf16 v[128:143], a[76:79], v[156:159], v[128:143]
    global_load_dwordx4 a[4:7], v1, s[36:37] offset:1024
    ds_write_b128 v13, v[100:103] offset:9216
    v_mfma_f32_32x32x16_bf16 v[128:143], a[80:83], v[160:163], v[128:143]
    v_fma_f32 v24, v112, v17, -0.5
    v_fma_f32 v25, v113, v17, -0.5
    v_fma_f32 v26, v114, v17, -0.5
    v_fma_f32 v27, v115, v17, -0.5
    v_exp_f32 v24, v24
    v_mfma_f32_32x32x16_bf16 v[128:143], a[84:87], v[164:167], v[128:143]
    v_exp_f32 v25, v25
    v_exp_f32 v26, v26
    v_exp_f32 v27, v27
    v_mfma_f32_32x32x16_bf16 v[128:143], a[88:91], v[168:171], v[128:143]
    global_load_dwordx4 a[8:11], v1, s[36:37] offset:2048
    s_waitcnt lgkmcnt(0)
    s_barrier
    v_add_f32 v24, s58, v24
    v_add_f32 v25, s58, v25
    v_add_f32 v26, s58, v26
    v_add_f32 v27, s58, v27
    v_mfma_f32_32x32x16_bf16 v[128:143], a[92:95], v[172:175], v[128:143]
    v_fma_f32 v24, -v24, v24, -0.5
    v_fma_f32 v25, -v25, v25, -0.5
    v_fma_f32 v26, -v26, v26, -0.5
    v_fma_f32 v27, -v27, v27, -0.5
    v_rcp_f32 v24, v24
    v_mfma_f32_32x32x16_bf16 v[128:143], a[96:99], v[176:179], v[128:143]
    global_load_dwordx4 a[12:15], v1, s[36:37] offset:3072
    v_rcp_f32 v25, v25
    v_rcp_f32 v26, v26
    v_rcp_f32 v27, v27
    v_mfma_f32_32x32x16_bf16 v[128:143], a[100:103], v[180:183], v[128:143]
    v_fmac_f32 v112, v112, v24
    v_fmac_f32 v113, v113, v25
    v_fmac_f32 v114, v114, v26
    v_fmac_f32 v115, v115, v27
    v_cvt_pk_bf16_f32 v112, v112, v113
    v_mfma_f32_32x32x16_bf16 v[128:143], a[104:107], v[184:187], v[128:143]
    v_cvt_pk_bf16_f32 v113, v114, v115
    v_fma_f32 v28, v116, v17, -0.5
    v_fma_f32 v29, v117, v17, -0.5
    v_fma_f32 v30, v118, v17, -0.5
    v_fma_f32 v31, v119, v17, -0.5
    v_exp_f32 v28, v28
    v_mfma_f32_32x32x16_bf16 v[128:143], a[108:111], v[188:191], v[128:143]
    global_load_dwordx4 a[16:19], v7, s[36:37] offset:-4096
    v_exp_f32 v29, v29
    v_exp_f32 v30, v30
    v_mfma_f32_32x32x16_bf16 v[128:143], a[112:115], v[192:195], v[128:143]
    v_exp_f32 v31, v31
    v_add_f32 v28, s58, v28
    v_add_f32 v29, s58, v29
    v_add_f32 v30, s58, v30
    v_add_f32 v31, s58, v31
    v_fma_f32 v28, -v28, v28, -0.5
    v_mfma_f32_32x32x16_bf16 v[128:143], a[116:119], v[196:199], v[128:143]
    global_load_dwordx4 a[20:23], v7, s[36:37] offset:-3072
    v_fma_f32 v29, -v29, v29, -0.5
    v_fma_f32 v30, -v30, v30, -0.5
    v_fma_f32 v31, -v31, v31, -0.5
    v_rcp_f32 v28, v28
    v_mfma_f32_32x32x16_bf16 v[128:143], a[120:123], v[200:203], v[128:143]
    s_waitcnt vmcnt(32)
    ds_read_b128 a[112:115], v18 offset:0
    v_rcp_f32 v29, v29
    v_rcp_f32 v30, v30
    v_mfma_f32_32x32x16_bf16 v[128:143], a[124:127], v[204:207], v[128:143]
    ds_read_b128 a[116:119], v18 offset:1024
    v_rcp_f32 v31, v31
    v_fmac_f32 v116, v116, v28
    v_fmac_f32 v117, v117, v29
    v_fmac_f32 v118, v118, v30
    v_fmac_f32 v119, v119, v31
    v_mfma_f32_32x32x16_bf16 v[128:143], a[128:131], v[208:211], v[128:143]
    global_load_dwordx4 a[24:27], v7, s[36:37] offset:-2048
    ds_read_b128 a[120:123], v18 offset:2048
    v_cvt_pk_bf16_f32 v114, v116, v117
    v_cvt_pk_bf16_f32 v115, v118, v119
    v_fma_f32 v24, v120, v17, -0.5
    v_mfma_f32_32x32x16_bf16 v[128:143], a[132:135], v[212:215], v[128:143]
    ds_read_b128 a[124:127], v18 offset:3072
    v_fma_f32 v25, v121, v17, -0.5
    v_fma_f32 v26, v122, v17, -0.5
    v_fma_f32 v27, v123, v17, -0.5
    v_exp_f32 v24, v24
    v_mfma_f32_32x32x16_bf16 v[128:143], a[136:139], v[216:219], v[128:143]
    global_load_dwordx4 a[28:31], v7, s[36:37] offset:-1024
    s_waitcnt vmcnt(29)
    ds_read_b128 a[128:131], v18 offset:4096
    ds_read_b128 v[144:147], v14 offset:0
    v_mfma_f32_32x32x16_bf16 v[128:143], a[140:143], v[220:223], v[128:143]
    ds_read_b128 a[132:135], v18 offset:5120
    ds_read_b128 v[148:151], v14 offset:1024
    v_exp_f32 v25, v25
    v_mfma_f32_32x32x16_bf16 v[128:143], a[144:147], v[224:227], v[128:143]
    ds_read_b128 a[136:139], v18 offset:6144
    ds_read_b128 v[152:155], v14 offset:2048
    v_exp_f32 v26, v26
    v_exp_f32 v27, v27
    v_mfma_f32_32x32x16_bf16 v[128:143], a[148:151], v[228:231], v[128:143]
    global_load_dwordx4 a[32:35], v7, s[36:37] offset:0
    ds_read_b128 a[140:143], v18 offset:7168
    ds_read_b128 v[156:159], v14 offset:3072
    v_mfma_f32_32x32x16_bf16 v[128:143], a[152:155], v[232:235], v[128:143]
    s_waitcnt vmcnt(26)
    ds_read_b128 a[144:147], v18 offset:8192
    ds_read_b128 v[160:163], v14 offset:4096
    v_add_f32 v24, s58, v24
    v_add_f32 v25, s58, v25
    v_mfma_f32_32x32x16_bf16 v[128:143], a[156:159], v[236:239], v[128:143]
    global_load_dwordx4 a[36:39], v7, s[36:37] offset:1024
    ds_read_b128 a[148:151], v18 offset:9216
    ds_read_b128 v[164:167], v14 offset:5120
    v_add_f32 v26, s58, v26
    v_mfma_f32_32x32x16_bf16 v[128:143], a[160:163], v[240:243], v[128:143]
    ds_read_b128 a[152:155], v18 offset:10240
    ds_read_b128 v[168:171], v14 offset:6144
    v_add_f32 v27, s58, v27
    v_fma_f32 v24, -v24, v24, -0.5
    v_fma_f32 v25, -v25, v25, -0.5
    v_mfma_f32_32x32x16_bf16 v[128:143], a[164:167], v[244:247], v[128:143]
    ds_read_b128 a[156:159], v18 offset:11264
    ds_read_b128 v[172:175], v14 offset:7168
    v_fma_f32 v26, -v26, v26, -0.5
    v_fma_f32 v27, -v27, v27, -0.5
    v_rcp_f32 v24, v24
    v_mfma_f32_32x32x16_bf16 v[128:143], a[168:171], v[248:251], v[128:143]
    global_load_dwordx4 a[40:43], v7, s[36:37] offset:2048
    s_waitcnt vmcnt(23)
    ds_read_b128 a[160:163], v18 offset:12288
    ds_read_b128 v[176:179], v14 offset:8192
    v_mfma_f32_32x32x16_bf16 v[128:143], a[172:175], v[252:255], v[128:143]
    ds_read_b128 a[164:167], v18 offset:13312
    ds_read_b128 v[180:183], v14 offset:9216
    v_rcp_f32 v25, v25
    v_mfma_f32_32x32x16_bf16 v[128:143], v[32:35], v[44:47], v[128:143]
    global_load_dwordx4 a[44:47], v7, s[36:37] offset:3072
    ds_read_b128 a[168:171], v18 offset:14336
    ds_read_b128 v[184:187], v14 offset:10240
    s_waitcnt lgkmcnt(15)
    v_mfma_f32_32x32x16_bf16 v[48:63], a[224:227], v[144:147], 0
    ds_read_b128 a[172:175], v18 offset:15360
    ds_read_b128 v[188:191], v14 offset:11264
    v_rcp_f32 v26, v26
    v_rcp_f32 v27, v27
    v_mfma_f32_32x32x16_bf16 v[48:63], a[228:231], v[148:151], v[48:63]
    ds_read_b128 v[192:195], v14 offset:12288
    v_fmac_f32 v120, v120, v24
    v_fmac_f32 v121, v121, v25
    v_fmac_f32 v122, v122, v26
    v_fmac_f32 v123, v123, v27
    s_waitcnt lgkmcnt(15)
    v_mfma_f32_32x32x16_bf16 v[48:63], a[232:235], v[152:155], v[48:63]
    global_load_dwordx4 a[48:51], v1, s[38:39] offset:-4096
    ds_read_b128 v[196:199], v14 offset:13312
    v_cvt_pk_bf16_f32 v116, v120, v121
    v_cvt_pk_bf16_f32 v117, v122, v123
    v_mfma_f32_32x32x16_bf16 v[48:63], a[236:239], v[156:159], v[48:63]
    ds_read_b128 v[200:203], v14 offset:14336
    v_fma_f32 v28, v124, v17, -0.5
    v_fma_f32 v29, v125, v17, -0.5
    v_fma_f32 v30, v126, v17, -0.5
    v_fma_f32 v31, v127, v17, -0.5
    v_exp_f32 v28, v28
    s_waitcnt lgkmcnt(15)
    v_mfma_f32_32x32x16_bf16 v[48:63], a[240:243], v[160:163], v[48:63]
    global_load_dwordx4 a[52:55], v1, s[38:39] offset:-3072
    ds_read_b128 v[204:207], v14 offset:15360
    v_exp_f32 v29, v29
    v_mfma_f32_32x32x16_bf16 v[48:63], a[244:247], v[164:167], v[48:63]
    v_exp_f32 v30, v30
    v_exp_f32 v31, v31
    v_add_f32 v28, s58, v28
    s_waitcnt lgkmcnt(12)
    v_mfma_f32_32x32x16_bf16 v[48:63], a[248:251], v[168:171], v[48:63]
    v_add_f32 v29, s58, v29
    v_add_f32 v30, s58, v30
    v_add_f32 v31, s58, v31
    v_fma_f32 v28, -v28, v28, -0.5
    v_fma_f32 v29, -v29, v29, -0.5
    v_mfma_f32_32x32x16_bf16 v[48:63], a[252:255], v[172:175], v[48:63]
    global_load_dwordx4 a[56:59], v1, s[38:39] offset:-2048
    v_fma_f32 v30, -v30, v30, -0.5
    v_fma_f32 v31, -v31, v31, -0.5
    v_rcp_f32 v28, v28
    v_rcp_f32 v29, v29
    s_waitcnt lgkmcnt(8)
    v_mfma_f32_32x32x16_bf16 v[48:63], a[112:115], v[176:179], v[48:63]
    v_rcp_f32 v30, v30
    v_rcp_f32 v31, v31
    v_fmac_f32 v124, v124, v28
    v_mfma_f32_32x32x16_bf16 v[48:63], a[116:119], v[180:183], v[48:63]
    global_load_dwordx4 a[60:63], v1, s[38:39] offset:-1024
    v_fmac_f32 v125, v125, v29
    v_fmac_f32 v126, v126, v30
    v_fmac_f32 v127, v127, v31
    v_cvt_pk_bf16_f32 v118, v124, v125
    v_cvt_pk_bf16_f32 v119, v126, v127
    s_waitcnt lgkmcnt(4)
    v_mfma_f32_32x32x16_bf16 v[48:63], a[120:123], v[184:187], v[48:63]
    ds_write_b128 v13, v[112:115] offset:24576
    ds_write_b128 v13, v[116:119] offset:25600
    v_mfma_f32_32x32x16_bf16 v[48:63], a[124:127], v[188:191], v[48:63]
    v_fma_f32 v24, v128, v17, -0.5
    v_fma_f32 v25, v129, v17, -0.5
    v_fma_f32 v26, v130, v17, -0.5
    s_waitcnt lgkmcnt(4)
    v_mfma_f32_32x32x16_bf16 v[48:63], a[128:131], v[192:195], v[48:63]
    global_load_dwordx4 a[64:67], v1, s[38:39] offset:0
    v_fma_f32 v27, v131, v17, -0.5
    v_exp_f32 v24, v24
    v_exp_f32 v25, v25
    v_mfma_f32_32x32x16_bf16 v[48:63], a[132:135], v[196:199], v[48:63]
    v_exp_f32 v26, v26
    v_exp_f32 v27, v27
    v_add_f32 v24, s58, v24
    v_add_f32 v25, s58, v25
    v_add_f32 v26, s58, v26
    s_waitcnt lgkmcnt(2)
    v_mfma_f32_32x32x16_bf16 v[48:63], a[136:139], v[200:203], v[48:63]
    global_load_dwordx4 a[68:71], v1, s[38:39] offset:1024
    v_add_f32 v27, s58, v27
    v_fma_f32 v24, -v24, v24, -0.5
    v_fma_f32 v25, -v25, v25, -0.5
    v_fma_f32 v26, -v26, v26, -0.5
    v_mfma_f32_32x32x16_bf16 v[48:63], a[140:143], v[204:207], v[48:63]
    v_fma_f32 v27, -v27, v27, -0.5
    v_rcp_f32 v24, v24
    v_rcp_f32 v25, v25
    v_rcp_f32 v26, v26
    v_mfma_f32_32x32x16_bf16 v[64:79], a[144:147], v[144:147], 0
    v_rcp_f32 v27, v27
    v_fmac_f32 v128, v128, v24
    v_fmac_f32 v129, v129, v25
    v_fmac_f32 v130, v130, v26
    v_mfma_f32_32x32x16_bf16 v[64:79], a[148:151], v[148:151], v[64:79]
    global_load_dwordx4 a[72:75], v1, s[38:39] offset:2048
    v_fmac_f32 v131, v131, v27
    v_cvt_pk_bf16_f32 v128, v128, v129
    v_cvt_pk_bf16_f32 v129, v130, v131
    v_fma_f32 v28, v132, v17, -0.5
    v_fma_f32 v29, v133, v17, -0.5
    v_mfma_f32_32x32x16_bf16 v[64:79], a[152:155], v[152:155], v[64:79]
    v_fma_f32 v30, v134, v17, -0.5
    v_fma_f32 v31, v135, v17, -0.5
    v_exp_f32 v28, v28
    v_exp_f32 v29, v29
    v_mfma_f32_32x32x16_bf16 v[64:79], a[156:159], v[156:159], v[64:79]
    global_load_dwordx4 a[76:79], v1, s[38:39] offset:3072
    v_exp_f32 v30, v30
    v_exp_f32 v31, v31
    v_add_f32 v28, s58, v28
    v_add_f32 v29, s58, v29
    v_mfma_f32_32x32x16_bf16 v[64:79], a[160:163], v[160:163], v[64:79]
    v_add_f32 v30, s58, v30
    v_add_f32 v31, s58, v31
    v_fma_f32 v28, -v28, v28, -0.5
    v_fma_f32 v29, -v29, v29, -0.5
    v_fma_f32 v30, -v30, v30, -0.5
    v_fma_f32 v31, -v31, v31, -0.5
    v_mfma_f32_32x32x16_bf16 v[64:79], a[164:167], v[164:167], v[64:79]
    v_rcp_f32 v28, v28
    v_rcp_f32 v29, v29
    v_rcp_f32 v30, v30
    v_mfma_f32_32x32x16_bf16 v[64:79], a[168:171], v[168:171], v[64:79]
    global_load_dwordx4 a[80:83], v7, s[38:39] offset:-4096
    v_rcp_f32 v31, v31
    v_fmac_f32 v132, v132, v28
    v_fmac_f32 v133, v133, v29
    v_fmac_f32 v134, v134, v30
    v_fmac_f32 v135, v135, v31
    v_mfma_f32_32x32x16_bf16 v[64:79], a[172:175], v[172:175], v[64:79]
    v_cvt_pk_bf16_f32 v130, v132, v133
    v_cvt_pk_bf16_f32 v131, v134, v135
    v_fma_f32 v24, v136, v17, -0.5
    v_fma_f32 v25, v137, v17, -0.5
    v_fma_f32 v26, v138, v17, -0.5
    s_waitcnt vmcnt(31)
    v_mfma_f32_32x32x16_bf16 v[64:79], a[176:179], v[176:179], v[64:79]
    global_load_dwordx4 a[84:87], v7, s[38:39] offset:-3072
    v_fma_f32 v27, v139, v17, -0.5
    v_exp_f32 v24, v24
    v_exp_f32 v25, v25
    v_mfma_f32_32x32x16_bf16 v[64:79], a[180:183], v[180:183], v[64:79]
    v_exp_f32 v26, v26
    v_exp_f32 v27, v27
    v_add_f32 v24, s58, v24
    v_add_f32 v25, s58, v25
    s_waitcnt vmcnt(30)
    v_mfma_f32_32x32x16_bf16 v[64:79], a[184:187], v[184:187], v[64:79]
    v_add_f32 v26, s58, v26
    v_add_f32 v27, s58, v27
    v_fma_f32 v24, -v24, v24, -0.5
    v_fma_f32 v25, -v25, v25, -0.5
    v_fma_f32 v26, -v26, v26, -0.5
    v_mfma_f32_32x32x16_bf16 v[64:79], a[188:191], v[188:191], v[64:79]
    global_load_dwordx4 a[88:91], v7, s[38:39] offset:-2048
    v_fma_f32 v27, -v27, v27, -0.5
    v_rcp_f32 v24, v24
    v_rcp_f32 v25, v25
    v_rcp_f32 v26, v26
    s_waitcnt vmcnt(29)
    v_mfma_f32_32x32x16_bf16 v[64:79], a[192:195], v[192:195], v[64:79]
    v_rcp_f32 v27, v27
    v_fmac_f32 v136, v136, v24
    v_fmac_f32 v137, v137, v25
    v_mfma_f32_32x32x16_bf16 v[64:79], a[196:199], v[196:199], v[64:79]
    global_load_dwordx4 a[92:95], v7, s[38:39] offset:-1024
    v_fmac_f32 v138, v138, v26
    v_fmac_f32 v139, v139, v27
    v_cvt_pk_bf16_f32 v132, v136, v137
    v_cvt_pk_bf16_f32 v133, v138, v139
    v_fma_f32 v28, v140, v17, -0.5
    s_waitcnt vmcnt(28)
    v_mfma_f32_32x32x16_bf16 v[64:79], a[200:203], v[200:203], v[64:79]
    v_fma_f32 v29, v141, v17, -0.5
    v_fma_f32 v30, v142, v17, -0.5
    v_fma_f32 v31, v143, v17, -0.5
    v_exp_f32 v28, v28
    v_mfma_f32_32x32x16_bf16 v[64:79], a[204:207], v[204:207], v[64:79]
    v_exp_f32 v29, v29
    v_exp_f32 v30, v30
    v_exp_f32 v31, v31
    v_add_f32 v28, s58, v28
    s_waitcnt vmcnt(26)
    v_mfma_f32_32x32x16_bf16 v[32:47], a[208:211], v[144:147], 0
    global_load_dwordx4 a[96:99], v7, s[38:39] offset:0
    v_add_f32 v29, s58, v29
    v_add_f32 v30, s58, v30
    v_add_f32 v31, s58, v31
    v_fma_f32 v28, -v28, v28, -0.5
    v_mfma_f32_32x32x16_bf16 v[32:47], a[212:215], v[148:151], v[32:47]
    v_fma_f32 v29, -v29, v29, -0.5
    v_fma_f32 v30, -v30, v30, -0.5
    v_fma_f32 v31, -v31, v31, -0.5
    v_rcp_f32 v28, v28
    v_rcp_f32 v29, v29
    s_waitcnt vmcnt(25)
    v_mfma_f32_32x32x16_bf16 v[32:47], a[216:219], v[152:155], v[32:47]
    global_load_dwordx4 a[100:103], v7, s[38:39] offset:1024
    global_load_ubyte v4, v10, s[66:67] offset:960 sc1
    v_rcp_f32 v30, v30
    v_mfma_f32_32x32x16_bf16 v[32:47], a[220:223], v[156:159], v[32:47]
    v_rcp_f32 v31, v31
    v_fmac_f32 v140, v140, v28
    v_fmac_f32 v141, v141, v29
    v_fmac_f32 v142, v142, v30
    v_fmac_f32 v143, v143, v31
    s_waitcnt vmcnt(25)
    v_mfma_f32_32x32x16_bf16 v[32:47], a[0:3], v[160:163], v[32:47]
    v_cvt_pk_bf16_f32 v48, v48, v49
    v_cvt_pk_bf16_f32 v49, v50, v51
    v_cvt_pk_bf16_f32 v50, v52, v53
    v_cvt_pk_bf16_f32 v51, v54, v55
    global_store_dwordx4 v12, v[48:51], s[40:41] offset:0 sc1
    v_mfma_f32_32x32x16_bf16 v[32:47], a[4:7], v[164:167], v[32:47]
    global_load_dwordx4 a[104:107], v7, s[38:39] offset:2048
    v_cvt_pk_bf16_f32 v52, v56, v57
    v_cvt_pk_bf16_f32 v53, v58, v59
    v_cvt_pk_bf16_f32 v54, v60, v61
    s_waitcnt vmcnt(25)
    v_mfma_f32_32x32x16_bf16 v[32:47], a[8:11], v[168:171], v[32:47]
    v_cvt_pk_bf16_f32 v55, v62, v63
    global_store_dwordx4 v12, v[52:55], s[40:41] offset:128 sc1
    v_mfma_f32_32x32x16_bf16 v[32:47], a[12:15], v[172:175], v[32:47]
    global_load_dwordx4 a[108:111], v7, s[38:39] offset:3072
    v_cvt_pk_bf16_f32 v134, v140, v141
    v_cvt_pk_bf16_f32 v135, v142, v143
    ds_write_b128 v13, v[128:131] offset:16384
    s_waitcnt vmcnt(25)
    v_mfma_f32_32x32x16_bf16 v[32:47], a[16:19], v[176:179], v[32:47]
    ds_write_b128 v13, v[132:135] offset:17408
    v_mfma_f32_32x32x16_bf16 v[32:47], a[20:23], v[180:183], v[32:47]
    s_waitcnt vmcnt(23)
    v_mfma_f32_32x32x16_bf16 v[32:47], a[24:27], v[184:187], v[32:47]
    v_mfma_f32_32x32x16_bf16 v[32:47], a[28:31], v[188:191], v[32:47]
    s_waitcnt lgkmcnt(0)
    s_barrier
    ds_read_b128 v[96:99], v15 offset:0
    s_waitcnt vmcnt(21)
    v_mfma_f32_32x32x16_bf16 v[32:47], a[32:35], v[192:195], v[32:47]
    ds_read_b128 v[100:103], v15 offset:1024
    v_mfma_f32_32x32x16_bf16 v[32:47], a[36:39], v[196:199], v[32:47]
    ds_read_b128 v[104:107], v15 offset:2048
    s_waitcnt vmcnt(4)
    v_cmp_ne_u32 vcc, 1, v4
    s_cbranch_vccnz KB_mkspin
KB_mkspin_done:
    v_mfma_f32_32x32x16_bf16 v[32:47], a[40:43], v[200:203], v[32:47]
    ds_read_b128 v[108:111], v15 offset:3072
    v_cvt_pk_bf16_f32 v64, v64, v65
    v_cvt_pk_bf16_f32 v65, v66, v67
    v_cvt_pk_bf16_f32 v66, v68, v69
    v_cvt_pk_bf16_f32 v67, v70, v71
    global_store_dwordx4 v12, v[64:67], s[40:41] offset:256 sc1
    v_mfma_f32_32x32x16_bf16 v[32:47], a[44:47], v[204:207], v[32:47]
    ds_read_b128 v[112:115], v15 offset:4096
    v_cvt_pk_bf16_f32 v68, v72, v73
    v_cvt_pk_bf16_f32 v69, v74, v75
    v_cvt_pk_bf16_f32 v70, v76, v77
    s_waitcnt lgkmcnt(3)
    v_mfma_f32_32x32x16_bf16 v[48:63], a[48:51], v[96:99], 0
    ds_read_b128 v[116:119], v15 offset:5120
    v_cvt_pk_bf16_f32 v71, v78, v79
    global_store_dwordx4 v12, v[68:71], s[40:41] offset:384 sc1
    v_mfma_f32_32x32x16_bf16 v[48:63], a[52:55], v[100:103], v[48:63]
    ds_read_b128 v[208:211], v14 offset:16384
    ds_read_b128 v[120:123], v15 offset:6144
    s_waitcnt lgkmcnt(4)
    v_mfma_f32_32x32x16_bf16 v[48:63], a[56:59], v[104:107], v[48:63]
    ds_read_b128 v[212:215], v14 offset:17408
    ds_read_b128 v[124:127], v15 offset:7168
    v_cvt_pk_bf16_f32 v32, v32, v33
    v_cvt_pk_bf16_f32 v33, v34, v35
    v_mfma_f32_32x32x16_bf16 v[48:63], a[60:63], v[108:111], v[48:63]
    ds_read_b128 v[216:219], v14 offset:18432
    ds_read_b128 v[96:99], v15 offset:8192
    v_cvt_pk_bf16_f32 v34, v36, v37
    v_cvt_pk_bf16_f32 v35, v38, v39
    global_store_dwordx4 v12, v[32:35], s[40:41] offset:512 sc1
    s_waitcnt lgkmcnt(6)
    v_mfma_f32_32x32x16_bf16 v[48:63], a[64:67], v[112:115], v[48:63]
    ds_read_b128 v[220:223], v14 offset:19456
    ds_read_b128 v[100:103], v15 offset:9216
    v_mfma_f32_32x32x16_bf16 v[48:63], a[68:71], v[116:119], v[48:63]
    ds_read_b128 v[224:227], v14 offset:20480
    ds_read_b128 v[104:107], v15 offset:10240
    v_cvt_pk_bf16_f32 v36, v40, v41
    v_cvt_pk_bf16_f32 v37, v42, v43
    s_waitcnt lgkmcnt(6)
    v_mfma_f32_32x32x16_bf16 v[48:63], a[72:75], v[120:123], v[48:63]
    ds_read_b128 v[228:231], v14 offset:21504
    ds_read_b128 v[108:111], v15 offset:11264
    v_cvt_pk_bf16_f32 v38, v44, v45
    v_cvt_pk_bf16_f32 v39, v46, v47
    v_mfma_f32_32x32x16_bf16 v[48:63], a[76:79], v[124:127], v[48:63]
    ds_read_b128 v[232:235], v14 offset:22528
    ds_read_b128 v[112:115], v15 offset:12288
    global_store_dwordx4 v12, v[36:39], s[40:41] offset:640 sc1
    s_waitcnt lgkmcnt(6)
    v_mfma_f32_32x32x16_bf16 v[48:63], a[80:83], v[96:99], v[48:63]
    ds_read_b128 v[236:239], v14 offset:23552
    ds_read_b128 v[116:119], v15 offset:13312
    v_mfma_f32_32x32x16_bf16 v[48:63], a[84:87], v[100:103], v[48:63]
    ds_read_b128 v[240:243], v14 offset:24576
    ds_read_b128 v[120:123], v15 offset:14336
    s_waitcnt lgkmcnt(6)
    v_mfma_f32_32x32x16_bf16 v[48:63], a[88:91], v[104:107], v[48:63]
    ds_read_b128 v[244:247], v14 offset:25600
    ds_read_b128 v[124:127], v15 offset:15360
    v_mfma_f32_32x32x16_bf16 v[48:63], a[92:95], v[108:111], v[48:63]
    ds_read_b128 v[248:251], v14 offset:26624
    s_waitcnt lgkmcnt(5)
    v_mfma_f32_32x32x16_bf16 v[48:63], a[96:99], v[112:115], v[48:63]
    ds_read_b128 v[252:255], v14 offset:27648
    v_mfma_f32_32x32x16_bf16 v[48:63], a[100:103], v[116:119], v[48:63]
    ds_read_b128 v[80:83], v14 offset:28672
    s_waitcnt vmcnt(4)
    s_waitcnt lgkmcnt(3)
    v_mfma_f32_32x32x16_bf16 v[48:63], a[104:107], v[120:123], v[48:63]
    ds_read_b128 v[84:87], v14 offset:29696
    s_mov_b32 s24, s12
    s_mov_b32 s25, s13
    s_mov_b32 s26, 1835008
    s_mov_b32 s27, 0x20000
    v_mfma_f32_32x32x16_bf16 v[48:63], a[108:111], v[124:127], v[48:63]
    ds_read_b128 v[88:91], v14 offset:30720
    s_mul_i32 s53, s4, 458752
    s_mul_i32 s52, s5, 57344
    s_add_u32 s53, s53, s52
    s_lshl_b32 s52, s3, 10
    s_add_u32 s53, s53, s52
    v_mfma_f32_32x32x16_bf16 v[64:79], a[224:227], v[208:211], 0
    ds_read_b128 v[92:95], v14 offset:31744
    s_add_u32 s53, s53, 11537920
    s_add_u32 s32, s8, s53
    s_addc_u32 s33, s9, 0
    s_add_u32 s34, s32, 10752
    s_addc_u32 s35, s33, 0
    s_add_u32 s36, s34, 10752
    v_mfma_f32_32x32x16_bf16 v[64:79], a[228:231], v[212:215], v[64:79]
    s_addc_u32 s37, s35, 0
    s_mul_i32 s60, s6, 8*896
    s_lshl_b32 s61, s3, 8
    s_add_u32 s60, s60, s61
    s_mov_b32 s62, 0x00003f80
    s_lshl_b32 s61, s5, 4
    v_mfma_f32_32x32x16_bf16 v[64:79], a[232:235], v[216:219], v[64:79]
    v_cvt_pk_bf16_f32 v48, v48, v49
    v_cvt_pk_bf16_f32 v49, v50, v51
    v_cvt_pk_bf16_f32 v50, v52, v53
    v_cvt_pk_bf16_f32 v51, v54, v55
    global_store_dwordx4 v22, v[48:51], s[44:45] offset:0 sc1
    v_mfma_f32_32x32x16_bf16 v[64:79], a[236:239], v[220:223], v[64:79]
    v_cvt_pk_bf16_f32 v52, v56, v57
    v_cvt_pk_bf16_f32 v53, v58, v59
    v_cvt_pk_bf16_f32 v54, v60, v61
    v_mfma_f32_32x32x16_bf16 v[64:79], a[240:243], v[224:227], v[64:79]
    v_cvt_pk_bf16_f32 v55, v62, v63
    global_store_dwordx4 v22, v[52:55], s[44:45] offset:128 sc1
    s_add_u32 s61, s61, 32256
    v_mfma_f32_32x32x16_bf16 v[64:79], a[244:247], v[228:231], v[64:79]
    v_lshl_add_u32 v16, v6, 2, s61
    s_cmp_eq_u32 s3, 3
    s_cselect_b32 s59, 0, -1
    s_cselect_b32 s58, 31, 63
    v_and_b32 v29, s58, v0
    v_lshlrev_b32 v17, 4, v29
    v_mfma_f32_32x32x16_bf16 v[64:79], a[248:251], v[232:235], v[64:79]
    v_and_b32 v30, 7, v0
    v_min_u32 v30, 6, v30
    v_lshlrev_b32 v30, 2, v30
    s_lshl_b32 s53, s3, 2
    v_lshrrev_b32 v20, 4, v29
    v_add_u32 v20, s53, v20
    v_mul_u32_u24 v29, 43, v20
    v_mfma_f32_32x32x16_bf16 v[64:79], a[252:255], v[236:239], v[64:79]
    v_lshrrev_b32 v29, 7, v29
    v_mul_u32_u24 v27, 3, v29
    v_sub_u32 v27, v20, v27
    s_lshl_b32 s52, s4, 16
    s_add_u32 s52, s52, 3072
    s_lshl_b32 s53, s5, 13
    v_mfma_f32_32x32x16_bf16 v[64:79], a[112:115], v[240:243], v[64:79]
    s_branch KB_sk3
KB_t3:
    s_branch KB_tret
KB_sk3:
    s_add_u32 s53, s53, s52
    s_add_u32 s61, s53, 7340032
    s_mul_i32 s7, s5, 7168
    s_add_u32 s52, s52, s7
    s_lshr_b32 s7, s5, 2
    s_mul_i32 s7, s7, 8192
    v_mfma_f32_32x32x16_bf16 v[64:79], a[116:119], v[244:247], v[64:79]
    s_add_u32 s52, s52, s7
    s_add_u32 s52, s52, 9437184
    v_mov_b32 v28, s52
    v_mov_b32 v24, s53
    v_cmp_eq_u32 vcc, 1, v27
    v_mov_b32 v25, s61
    s_waitcnt lgkmcnt(4)
    v_mfma_f32_32x32x16_bf16 v[64:79], a[120:123], v[248:251], v[64:79]
    s_add_u32 s52, s53, 28311552
    v_cndmask_b32 v28, v28, v24, vcc
    v_cmp_eq_u32 vcc, 2, v27
    v_mov_b32 v24, s52
    v_add_u32 v27, -12, v20
    v_cndmask_b32 v28, v28, v25, vcc
    v_mfma_f32_32x32x16_bf16 v[64:79], a[124:127], v[252:255], v[64:79]
    v_cmp_lt_u32 vcc, 11, v20
    v_and_b32 v25, 15, v0
    s_nop 0
    v_cndmask_b32 v28, v28, v24, vcc
    v_cndmask_b32 v29, v29, v27, vcc
    v_lshl_add_u32 v28, v29, 8, v28
    s_waitcnt lgkmcnt(2)
    v_mfma_f32_32x32x16_bf16 v[64:79], a[128:131], v[80:83], v[64:79]
    v_lshl_add_u32 v28, v25, 4, v28
    s_lshl_b32 s53, s3, 13
    s_lshl_b32 s52, s5, 6
    s_add_u32 s53, s53, s52
    v_lshrrev_b32 v13, 3, v0
    v_mfma_f32_32x32x16_bf16 v[64:79], a[132:135], v[84:87], v[64:79]
    v_bfe_u32 v14, v0, 2, 1
    v_lshl_add_u32 v15, v13, 10, s53
    v_lshl_add_u32 v15, v14, 9, v15
    v_lshl_add_u32 v15, v6, 4, v15
    v_mul_u32_u24 v26, 896, v6
    v_lshl_add_u32 v26, v13, 5, v26
    v_lshl_add_u32 v26, v14, 4, v26
    s_waitcnt lgkmcnt(0)
    v_mfma_f32_32x32x16_bf16 v[64:79], a[136:139], v[88:91], v[64:79]
    ds_read_b128 v[200:203], v15 offset:0
    ds_read_b128 v[204:207], v15 offset:36864
    v_mfma_f32_32x32x16_bf16 v[64:79], a[140:143], v[92:95], v[64:79]
    s_waitcnt lgkmcnt(0)
    v_lshlrev_b32 v96, 16, v200
    v_and_b32 v97, 0xffff0000, v200
    v_lshlrev_b32 v98, 16, v201
    v_and_b32 v99, 0xffff0000, v201
    v_lshlrev_b32 v100, 16, v202
    v_and_b32 v101, 0xffff0000, v202
    v_mfma_f32_32x32x16_bf16 v[32:47], a[144:147], v[208:211], 0
    v_lshlrev_b32 v102, 16, v203
    v_and_b32 v103, 0xffff0000, v203
    v_lshlrev_b32 v104, 16, v204
    v_and_b32 v105, 0xffff0000, v204
    v_lshlrev_b32 v106, 16, v205
    v_and_b32 v107, 0xffff0000, v205
    v_mfma_f32_32x32x16_bf16 v[32:47], a[148:151], v[212:215], v[32:47]
    v_lshlrev_b32 v108, 16, v206
    v_and_b32 v109, 0xffff0000, v206
    v_lshlrev_b32 v110, 16, v207
    v_and_b32 v111, 0xffff0000, v207
    v_and_b32 v24, 1, v5
    v_lshlrev_b32 v24, 4, v24
    v_mfma_f32_32x32x16_bf16 v[32:47], a[152:155], v[216:219], v[32:47]
    v_cvt_pk_bf16_f32 v64, v64, v65
    v_cvt_pk_bf16_f32 v65, v66, v67
    v_cvt_pk_bf16_f32 v66, v68, v69
    v_cvt_pk_bf16_f32 v67, v70, v71
    global_store_dwordx4 v3, v[64:67], s[42:43] offset:0
    v_mfma_f32_32x32x16_bf16 v[32:47], a[156:159], v[220:223], v[32:47]
    v_cvt_pk_bf16_f32 v68, v72, v73
    v_cvt_pk_bf16_f32 v69, v74, v75
    v_cvt_pk_bf16_f32 v70, v76, v77
    v_mfma_f32_32x32x16_bf16 v[32:47], a[160:163], v[224:227], v[32:47]
    v_cvt_pk_bf16_f32 v71, v78, v79
    global_store_dwordx4 v3, v[68:71], s[42:43] offset:128
    v_lshlrev_b32 v24, v24, s62
    v_mfma_f32_32x32x16_bf16 v[32:47], a[164:167], v[228:231], v[32:47]
    v_lshrrev_b32 v25, 3, v5
    v_bfe_u32 v27, v5, 1, 1
    v_lshl_add_u32 v25, v25, 1, v27
    v_bfe_u32 v27, v5, 2, 1
    v_xor_b32 v27, v27, v2
    v_lshl_add_u32 v25, v27, 3, v25
    v_mfma_f32_32x32x16_bf16 v[32:47], a[168:171], v[232:235], v[32:47]
    v_cmp_eq_u32 s[48:49], 0, v25
    v_cmp_eq_u32 s[56:57], 1, v25
    v_cmp_eq_u32 s[62:63], 2, v25
    v_cmp_eq_u32 s[52:53], 3, v25
    v_cndmask_b32 v200, 0, v24, s[48:49]
    v_cndmask_b32 v201, 0, v24, s[56:57]
    v_cndmask_b32 v202, 0, v24, s[62:63]
    v_mfma_f32_32x32x16_bf16 v[32:47], a[172:175], v[236:239], v[32:47]
    v_cndmask_b32 v203, 0, v24, s[52:53]
    v_mfma_f32_32x32x16_bf16 v[32:47], a[176:179], v[240:243], v[32:47]
    s_waitcnt vmcnt(4)
    s_mov_b64 exec, 1
    global_store_byte v10, v11, s[66:67] offset:768
    s_mov_b64 exec, -1
    v_mfma_f32_32x32x16_bf16 v[32:47], a[180:183], v[244:247], v[32:47]
    v_mfma_f32_32x32x16_bf16 v[32:47], a[184:187], v[248:251], v[32:47]
    v_mfma_f32_32x32x16_bf16 v[32:47], a[188:191], v[252:255], v[32:47]
    v_mfma_f32_32x32x16_bf16 v[32:47], a[192:195], v[80:83], v[32:47]
    v_mfma_f32_32x32x16_bf16 v[32:47], a[196:199], v[84:87], v[32:47]
    v_mfma_f32_32x32x16_bf16 v[32:47], a[200:203], v[88:91], v[32:47]
    v_mfma_f32_32x32x16_bf16 v[32:47], a[204:207], v[92:95], v[32:47]
    global_load_dword v31, v30, s[66:67] offset:768 sc1
    v_mfma_f32_32x32x16_bf16 v[48:63], a[208:211], v[208:211], 0
    v_mfma_f32_32x32x16_bf16 v[48:63], a[212:215], v[212:215], v[48:63]
    v_mfma_f32_32x32x16_bf16 v[48:63], a[216:219], v[216:219], v[48:63]
    v_cvt_pk_bf16_f32 v32, v32, v33
    v_cvt_pk_bf16_f32 v33, v34, v35
    v_cvt_pk_bf16_f32 v34, v36, v37
    v_cvt_pk_bf16_f32 v35, v38, v39
    global_store_dwordx4 v23, v[32:35], s[20:21] offset:0
    v_mfma_f32_32x32x16_bf16 v[48:63], a[220:223], v[220:223], v[48:63]
    v_cvt_pk_bf16_f32 v36, v40, v41
    v_cvt_pk_bf16_f32 v37, v42, v43
    v_cvt_pk_bf16_f32 v38, v44, v45
    v_mfma_f32_32x32x16_bf16 v[48:63], a[0:3], v[224:227], v[48:63]
    v_cvt_pk_bf16_f32 v39, v46, v47
    global_store_dwordx4 v23, v[36:39], s[20:21] offset:128
    v_mfma_f32_32x32x16_bf16 v[48:63], a[4:7], v[228:231], v[48:63]
    v_mfma_f32_32x32x16_bf16 v[48:63], a[8:11], v[232:235], v[48:63]
    s_waitcnt vmcnt(2)
    v_cmp_ne_u32 vcc, 0x01010101, v31
    s_cmp_lg_u32 s68, 0
    s_cselect_b64 s[46:47], 0, -1
    s_or_b64 vcc, vcc, s[46:47]
    s_cselect_b64 s[46:47], 0, -1
    v_mfma_f32_32x32x16_bf16 v[48:63], a[12:15], v[236:239], v[48:63]
    s_mov_b64 exec, s[46:47]
    global_load_dword v18, v16, s[54:55] offset:0 sc1
    global_load_dword v19, v16, s[54:55] offset:128 sc1
    s_mov_b64 exec, -1
    v_mfma_f32_32x32x16_bf16 v[48:63], a[16:19], v[240:243], v[48:63]
    s_mov_b64 exec, s[46:47]
    global_load_dwordx4 v[144:147], v17, s[32:33] offset:-3584 sc1
    global_load_dwordx4 v[148:151], v17, s[32:33] offset:0 sc1
    s_mov_b64 exec, -1
    v_mfma_f32_32x32x16_bf16 v[48:63], a[20:23], v[244:247], v[48:63]
    s_mov_b64 exec, s[46:47]
    global_load_dwordx4 v[152:155], v17, s[32:33] offset:3584 sc1
    global_load_dwordx4 v[156:159], v17, s[34:35] offset:-3584 sc1
    s_mov_b64 exec, -1
    v_mfma_f32_32x32x16_bf16 v[48:63], a[24:27], v[248:251], v[48:63]
    s_mov_b64 exec, s[46:47]
    global_load_dwordx4 v[160:163], v17, s[34:35] offset:0 sc1
    global_load_dwordx4 v[164:167], v17, s[34:35] offset:3584 sc1
    s_mov_b64 exec, -1
    v_mfma_f32_32x32x16_bf16 v[48:63], a[28:31], v[252:255], v[48:63]
    s_mov_b64 exec, s[46:47]
    global_load_dwordx4 v[168:171], v17, s[36:37] offset:-3584 sc1
    s_mov_b64 exec, -1
    v_mfma_f32_32x32x16_bf16 v[48:63], a[32:35], v[80:83], v[48:63]
    v_mfma_f32_32x32x16_bf16 v[48:63], a[36:39], v[84:87], v[48:63]
    global_load_dword v31, v30, s[66:67] offset:768 sc1
    v_mfma_f32_32x32x16_bf16 v[48:63], a[40:43], v[88:91], v[48:63]
    v_mfma_f32_32x32x16_bf16 v[48:63], a[44:47], v[92:95], v[48:63]
    s_nop 7
    s_nop 3
    v_cvt_pk_bf16_f32 v48, v48, v49
    v_cvt_pk_bf16_f32 v49, v50, v51
    v_cvt_pk_bf16_f32 v50, v52, v53
    v_cvt_pk_bf16_f32 v51, v54, v55
    global_store_dwordx4 v23, v[48:51], s[22:23] offset:0
    v_cvt_pk_bf16_f32 v52, v56, v57
    v_cvt_pk_bf16_f32 v53, v58, v59
    v_cvt_pk_bf16_f32 v54, v60, v61
    v_cvt_pk_bf16_f32 v55, v62, v63
    global_store_dwordx4 v23, v[52:55], s[22:23] offset:128
    s_cmp_eq_u32 s68, 0
    s_cbranch_scc1 KB_fz
    s_barrier
    s_cmp_eq_u64 s[46:47], 0
    s_cbranch_scc1 KB_p0spin
KB_ld1:
    global_load_dwordx4 v[172:175], v28, s[8:9] offset:-3072 sc1
    global_load_dwordx4 v[176:179], v28, s[8:9] offset:-2048 sc1
    global_load_dwordx4 v[180:183], v28, s[8:9] offset:-1024 sc1
    global_load_dwordx4 v[184:187], v28, s[8:9] offset:0 sc1
    global_load_dwordx4 v[188:191], v28, s[8:9] offset:1024 sc1
    global_load_dwordx4 v[192:195], v28, s[8:9] offset:2048 sc1
    global_load_dwordx4 v[196:199], v28, s[8:9] offset:3072 sc1
    s_waitcnt vmcnt(10)
    v_max3_u32 v20, v144, v148, v152
    v_max3_u32 v21, v156, v160, v164
    v_max3_u32 v20, v20, v21, v168
    v_cmp_eq_u32 vcc, -1, v20
    s_cbranch_vccnz KB_re0
KB_go:
    v_mfma_f32_32x32x16_bf16 v[112:127], v[200:203], v[144:147], 0
    v_mul_f32 v18, 0x3f317218, v18
    v_mul_f32 v19, 0x3f317218, v19
    v_mfma_f32_32x32x16_bf16 v[112:127], v[200:203], v[148:151], v[112:127]
    v_mfma_f32_32x32x16_bf16 v[112:127], v[200:203], v[152:155], v[112:127]
    v_mfma_f32_32x32x16_bf16 v[112:127], v[200:203], v[156:159], v[112:127]
    s_waitcnt vmcnt(0)
    s_mov_b64 exec, 1
    global_store_byte v10, v11, s[66:67] offset:384
    s_mov_b64 exec, -1
    v_max3_u32 v20, v172, v176, v180
    v_max3_u32 v21, v184, v188, v192
    v_max3_u32 v20, v20, v21, v196
    v_cmp_eq_u32 vcc, -1, v20
    v_mfma_f32_32x32x16_bf16 v[112:127], v[200:203], v[160:163], v[112:127]
    v_mfma_f32_32x32x16_bf16 v[112:127], v[200:203], v[164:167], v[112:127]
    v_mfma_f32_32x32x16_bf16 v[112:127], v[200:203], v[168:171], v[112:127]
    s_cbranch_vccnz KB_re1
KB_go1:
    v_mfma_f32_32x32x16_bf16 v[128:143], v[200:203], v[172:175], 0
    v_mfma_f32_32x32x16_bf16 v[128:143], v[200:203], v[176:179], v[128:143]
    v_fmac_f32 v96, v18, v112
    v_fmac_f32 v97, v18, v113
    v_fmac_f32 v98, v18, v114
    v_fmac_f32 v99, v18, v115
    v_fmac_f32 v100, v18, v116
    v_mfma_f32_32x32x16_bf16 v[128:143], v[200:203], v[180:183], v[128:143]
    v_fmac_f32 v101, v18, v117
    v_fmac_f32 v102, v18, v118
    v_fmac_f32 v103, v18, v119
    v_cvt_pk_bf16_f32 v32, v96, v97
    v_cvt_pk_bf16_f32 v33, v98, v99
    v_mfma_f32_32x32x16_bf16 v[128:143], v[200:203], v[184:187], v[128:143]
    v_cvt_pk_bf16_f32 v34, v100, v101
    v_cvt_pk_bf16_f32 v35, v102, v103
    v_mov_b32 v40, v34
    v_mov_b32 v41, v35
    s_nop 0
    v_mfma_f32_32x32x16_bf16 v[128:143], v[200:203], v[188:191], v[128:143]
    v_mov_b32_dpp v34, v32 row_shl:4 row_mask:0xf bank_mask:0x5
    v_mov_b32_dpp v35, v33 row_shl:4 row_mask:0xf bank_mask:0x5
    v_mov_b32_dpp v32, v40 row_shr:4 row_mask:0xf bank_mask:0xa
    v_mov_b32_dpp v33, v41 row_shr:4 row_mask:0xf bank_mask:0xa
    v_mfma_f32_32x32x16_bf16 v[128:143], v[200:203], v[192:195], v[128:143]
    s_mov_b32 exec_hi, s59
    buffer_store_dwordx4 v[32:35], v26, s[24:27], s60 offen offset:0
    s_mov_b32 exec_hi, -1
    v_mfma_f32_32x32x16_bf16 v[128:143], v[200:203], v[196:199], v[128:143]
    s_nop 7
    s_nop 7
    v_fmac_f32 v104, v19, v128
    v_fmac_f32 v105, v19, v129
    v_fmac_f32 v106, v19, v130
    v_fmac_f32 v107, v19, v131
    v_fmac_f32 v108, v19, v132
    v_fmac_f32 v109, v19, v133
    v_fmac_f32 v110, v19, v134
    v_fmac_f32 v111, v19, v135
    v_cvt_pk_bf16_f32 v36, v104, v105
    v_cvt_pk_bf16_f32 v37, v106, v107
    v_cvt_pk_bf16_f32 v38, v108, v109
    v_cvt_pk_bf16_f32 v39, v110, v111
    v_mov_b32 v40, v38
    v_mov_b32 v41, v39
    s_nop 0
    v_mov_b32_dpp v38, v36 row_shl:4 row_mask:0xf bank_mask:0x5
    v_mov_b32_dpp v39, v37 row_shl:4 row_mask:0xf bank_mask:0x5
    v_mov_b32_dpp v36, v40 row_shr:4 row_mask:0xf bank_mask:0xa
    v_mov_b32_dpp v37, v41 row_shr:4 row_mask:0xf bank_mask:0xa
    s_mov_b32 exec_hi, s59
    buffer_store_dwordx4 v[36:39], v26, s[24:27], s60 offen offset:3584
    s_endpgm
KB_re1:
    s_mov_b32 s7, 0
    s_mov_b32 s52, 0
KB_re1_l:
    global_load_dword v31, v30, s[66:67] offset:384 sc1
    global_load_dwordx4 v[172:175], v28, s[8:9] offset:-3072 sc1
    global_load_dwordx4 v[176:179], v28, s[8:9] offset:-2048 sc1
    global_load_dwordx4 v[180:183], v28, s[8:9] offset:-1024 sc1
    global_load_dwordx4 v[184:187], v28, s[8:9] offset:0 sc1
    global_load_dwordx4 v[188:191], v28, s[8:9] offset:1024 sc1
    global_load_dwordx4 v[192:195], v28, s[8:9] offset:2048 sc1
    global_load_dwordx4 v[196:199], v28, s[8:9] offset:3072 sc1
    s_add_u32 s52, s52, 1
    s_waitcnt vmcnt(0)
    v_max3_u32 v20, v172, v176, v180
    v_max3_u32 v21, v184, v188, v192
    v_max3_u32 v20, v20, v21, v196
    v_cmp_eq_u32 vcc, -1, v20
    s_cbranch_vccz KB_go1
    s_cmp_lg_u32 s7, 0
    s_cbranch_scc1 KB_go1
    v_cmp_ne_u32 vcc, 0x01010101, v31
    s_cmp_lt_u32 s52, 131072
    s_cbranch_scc0 KB_go1
    s_cbranch_vccnz KB_re1_l
    s_mov_b32 s7, 1
    s_branch KB_re1_l
KB_re0:
    s_waitcnt vmcnt(0)
    s_mov_b64 exec, 1
    global_store_byte v10, v11, s[66:67] offset:384
    s_mov_b64 exec, -1
    s_mov_b32 s7, 0
    s_mov_b32 s52, 0
KB_re0_l:
    global_load_dword v31, v30, s[66:67] offset:384 sc1
    global_load_dwordx4 v[144:147], v17, s[32:33] offset:-3584 sc1
    global_load_dwordx4 v[148:151], v17, s[32:33] offset:0 sc1
    global_load_dwordx4 v[152:155], v17, s[32:33] offset:3584 sc1
    global_load_dwordx4 v[156:159], v17, s[34:35] offset:-3584 sc1
    global_load_dwordx4 v[160:163], v17, s[34:35] offset:0 sc1
    global_load_dwordx4 v[164:167], v17, s[34:35] offset:3584 sc1
    global_load_dwordx4 v[168:171], v17, s[36:37] offset:-3584 sc1
    s_add_u32 s52, s52, 1
    s_waitcnt vmcnt(0)
    v_max3_u32 v20, v144, v148, v152
    v_max3_u32 v21, v156, v160, v164
    v_max3_u32 v20, v20, v21, v168
    v_cmp_eq_u32 vcc, -1, v20
    s_cbranch_vccz KB_go
    s_cmp_lg_u32 s7, 0
    s_cbranch_scc1 KB_go
    v_cmp_ne_u32 vcc, 0x01010101, v31
    s_cmp_lt_u32 s52, 131072
    s_cbranch_scc0 KB_go
    s_cbranch_vccnz KB_re0_l
    s_mov_b32 s7, 1
    s_branch KB_re0_l
KB_p0spin:
    s_waitcnt vmcnt(2)
    v_cmp_ne_u32 vcc, 0x01010101, v31
    s_cbranch_vccz KB_p0spin_d
KB_p0spin_m:
    s_mov_b32 s52, 0
KB_p0spin_l:
    global_load_dword v31, v30, s[66:67] offset:768 sc1
    s_add_u32 s52, s52, 1
    s_waitcnt vmcnt(0)
    v_cmp_ne_u32 vcc, 0x01010101, v31
    s_cbranch_vccz KB_p0spin_d
    s_cmp_lt_u32 s52, 131072
    s_cbranch_scc1 KB_p0spin_l
KB_p0spin_d:
    global_load_dword v18, v16, s[54:55] offset:0 sc1
    global_load_dword v19, v16, s[54:55] offset:128 sc1
    global_load_dwordx4 v[144:147], v17, s[32:33] offset:-3584 sc1
    global_load_dwordx4 v[148:151], v17, s[32:33] offset:0 sc1
    global_load_dwordx4 v[152:155], v17, s[32:33] offset:3584 sc1
    global_load_dwordx4 v[156:159], v17, s[34:35] offset:-3584 sc1
    global_load_dwordx4 v[160:163], v17, s[34:35] offset:0 sc1
    global_load_dwordx4 v[164:167], v17, s[34:35] offset:3584 sc1
    global_load_dwordx4 v[168:171], v17, s[36:37] offset:-3584 sc1
    global_load_dword v4, v16, s[54:55] sc1
    global_load_dword v4, v16, s[54:55] sc1
    global_load_dword v4, v16, s[54:55] sc1
    s_branch KB_ld1
KB_end:
    s_endpgm
KB_m7:
    v_lshlrev_b32 v12, 7, v0
    v_mov_b32 v13, 0
    s_cmp_eq_u32 s4, 0
    s_cselect_b64 exec, 3, 0
    global_store_dword v12, v13, s[92:93] sc0 sc1
    s_mov_b64 exec, -1
    s_lshl_b32 s53, s4, 16
    s_lshl_b32 s52, s3, 14
    s_add_u32 s61, s53, s52
    s_add_u32 s56, s8, s61
    s_addc_u32 s57, s9, 0
    v_lshlrev_b32 v12, 7, v0
    global_load_dword v4, v12, s[56:57] sc1
    s_add_u32 s48, s56, 8192
    s_addc_u32 s49, s57, 0
    global_load_dword v4, v12, s[48:49] sc1
    s_and_b32 s53, s4, 3
    s_lshl_b32 s53, s53, 2
    s_add_u32 s53, s53, s3
    s_mul_i32 s53, s53, 100352
    s_add_u32 s53, s53, 5242880
    s_add_u32 s56, s8, s53
    s_addc_u32 s57, s9, 0
    v_lshlrev_b32 v12, 7, v0
    s_mov_b32 s24, s12
    s_mov_b32 s25, s13
    s_mov_b32 s26, 1835008
    s_mov_b32 s27, 0x20000
    s_mul_i32 s53, s4, 458752
    s_mul_i32 s52, s5, 57344
    s_add_u32 s53, s53, s52
    s_lshl_b32 s52, s3, 10
    s_add_u32 s53, s53, s52
    s_add_u32 s53, s53, 11537920
    s_add_u32 s32, s8, s53
    s_addc_u32 s33, s9, 0
    s_add_u32 s34, s32, 10752
    s_addc_u32 s35, s33, 0
    s_add_u32 s36, s34, 10752
    s_addc_u32 s37, s35, 0
    s_mul_i32 s60, s6, 8*896
    s_lshl_b32 s61, s3, 8
    s_add_u32 s60, s60, s61
    s_mov_b32 s62, 0x00003f80
    s_lshl_b32 s61, s5, 4
    s_add_u32 s61, s61, 32256
    v_lshl_add_u32 v16, v6, 2, s61
    s_cmp_eq_u32 s3, 3
    s_cselect_b32 s59, 0, -1
    s_cselect_b32 s58, 31, 63
    v_and_b32 v29, s58, v0
    v_lshlrev_b32 v17, 4, v29
    v_and_b32 v30, 7, v0
    v_min_u32 v30, 6, v30
    v_lshlrev_b32 v30, 2, v30
    s_lshl_b32 s53, s3, 2
    v_lshrrev_b32 v20, 4, v29
    v_add_u32 v20, s53, v20
    v_mul_u32_u24 v29, 43, v20
    v_lshrrev_b32 v29, 7, v29
    v_mul_u32_u24 v27, 3, v29
    v_sub_u32 v27, v20, v27
    s_lshl_b32 s52, s4, 16
    s_add_u32 s52, s52, 3072
    s_lshl_b32 s53, s5, 13
    s_add_u32 s53, s53, s52
    s_add_u32 s61, s53, 7340032
    s_mul_i32 s7, s5, 7168
    s_add_u32 s52, s52, s7
    s_lshr_b32 s7, s5, 2
    s_mul_i32 s7, s7, 8192
    s_add_u32 s52, s52, s7
    s_add_u32 s52, s52, 9437184
    v_mov_b32 v28, s52
    v_mov_b32 v24, s53
    v_cmp_eq_u32 vcc, 1, v27
    v_mov_b32 v25, s61
    s_add_u32 s52, s53, 28311552
    v_cndmask_b32 v28, v28, v24, vcc
    v_cmp_eq_u32 vcc, 2, v27
    v_mov_b32 v24, s52
    v_add_u32 v27, -12, v20
    v_cndmask_b32 v28, v28, v25, vcc
    v_cmp_lt_u32 vcc, 11, v20
    v_and_b32 v25, 15, v0
    s_nop 0
    v_cndmask_b32 v28, v28, v24, vcc
    v_cndmask_b32 v29, v29, v27, vcc
    v_lshl_add_u32 v28, v29, 8, v28
    v_lshl_add_u32 v28, v25, 4, v28
    s_lshl_b32 s53, s3, 13
    s_lshl_b32 s52, s5, 6
    s_add_u32 s53, s53, s52
    v_lshrrev_b32 v13, 3, v0
    v_bfe_u32 v14, v0, 2, 1
    v_lshl_add_u32 v15, v13, 10, s53
    v_lshl_add_u32 v15, v14, 9, v15
    v_lshl_add_u32 v15, v6, 4, v15
    v_mul_u32_u24 v26, 896, v6
    v_lshl_add_u32 v26, v13, 5, v26
    v_lshl_add_u32 v26, v14, 4, v26
    s_add_u32 s50, s54, 36864
    s_addc_u32 s51, s55, 0
    s_cmp_eq_u32 s68, 0
    s_cbranch_scc1 KB_m7z
    v_mov_b32 v32, -1
    v_mov_b32 v33, -1
    v_mov_b32 v34, -1
    v_mov_b32 v35, -1
    s_mul_i32 s53, s4, 458752
    s_mul_i32 s52, s3, 2*57344
    s_add_u32 s53, s53, s52
    s_add_u32 s53, s53, 11537408
    s_add_u32 s56, s8, s53
    s_addc_u32 s57, s9, 0
    v_mul_u32_u24 v12, 3584 - 512, v2
    v_add_u32 v12, v12, v1
    global_store_dwordx4 v12, v[32:35], s[56:57] sc1
    s_add_u32 s56, s56, 7168
    s_addc_u32 s57, s57, 0
    global_store_dwordx4 v12, v[32:35], s[56:57] sc1
    s_add_u32 s56, s56, 7168
    s_addc_u32 s57, s57, 0
    global_store_dwordx4 v12, v[32:35], s[56:57] sc1
    s_add_u32 s56, s56, 7168
    s_addc_u32 s57, s57, 0
    global_store_dwordx4 v12, v[32:35], s[56:57] sc1
    s_add_u32 s56, s56, 35840
    s_addc_u32 s57, s57, 0
    global_store_dwordx4 v12, v[32:35], s[56:57] sc1
    s_add_u32 s56, s56, 7168
    s_addc_u32 s57, s57, 0
    global_store_dwordx4 v12, v[32:35], s[56:57] sc1
    s_add_u32 s56, s56, 7168
    s_addc_u32 s57, s57, 0
    global_store_dwordx4 v12, v[32:35], s[56:57] sc1
    s_add_u32 s56, s56, 7168
    s_addc_u32 s57, s57, 0
    global_store_dwordx4 v12, v[32:35], s[56:57] sc1
    s_add_u32 s56, s56, 7168
    s_addc_u32 s57, s57, 0
    s_lshl_b32 s53, s4, 16
    s_lshl_b32 s52, s3, 14
    s_add_u32 s61, s53, s52
    s_add_u32 s53, s61, 28311552
    s_add_u32 s56, s8, s53
    s_addc_u32 s57, s9, 0
    v_lshl_add_u32 v12, v2, 9, v1
    global_store_dwordx4 v12, v[32:35], s[56:57] offset:0 sc1
    global_store_dwordx4 v12, v[32:35], s[56:57] offset:2048 sc1
    s_add_u32 s56, s56, 4096
    s_addc_u32 s57, s57, 0
    global_store_dwordx4 v12, v[32:35], s[56:57] offset:0 sc1
    global_store_dwordx4 v12, v[32:35], s[56:57] offset:2048 sc1
    s_add_u32 s56, s56, 4096
    s_addc_u32 s57, s57, 0
    global_store_dwordx4 v12, v[32:35], s[56:57] offset:0 sc1
    global_store_dwordx4 v12, v[32:35], s[56:57] offset:2048 sc1
    s_add_u32 s56, s56, 4096
    s_addc_u32 s57, s57, 0
    global_store_dwordx4 v12, v[32:35], s[56:57] offset:0 sc1
    global_store_dwordx4 v12, v[32:35], s[56:57] offset:2048 sc1
    s_add_u32 s56, s56, 4096
    s_addc_u32 s57, s57, 0
    s_add_u32 s56, s8, s61
    s_addc_u32 s57, s9, 0
    s_waitcnt vmcnt(16)
    global_store_dwordx4 v1, v[32:35], s[56:57] offset:0
    global_store_dwordx4 v1, v[32:35], s[56:57] offset:1024
    global_store_dwordx4 v1, v[32:35], s[56:57] offset:2048
    global_store_dwordx4 v1, v[32:35], s[56:57] offset:3072
    s_add_u32 s56, s56, 4096
    s_addc_u32 s57, s57, 0
    global_store_dwordx4 v1, v[32:35], s[56:57] offset:0
    global_store_dwordx4 v1, v[32:35], s[56:57] offset:1024
    global_store_dwordx4 v1, v[32:35], s[56:57] offset:2048
    global_store_dwordx4 v1, v[32:35], s[56:57] offset:3072
    s_add_u32 s56, s56, 4096
    s_addc_u32 s57, s57, 0
    global_store_dwordx4 v1, v[32:35], s[56:57] offset:0
    global_store_dwordx4 v1, v[32:35], s[56:57] offset:1024
    global_store_dwordx4 v1, v[32:35], s[56:57] offset:2048
    global_store_dwordx4 v1, v[32:35], s[56:57] offset:3072
    s_add_u32 s56, s56, 4096
    s_addc_u32 s57, s57, 0
    global_store_dwordx4 v1, v[32:35], s[56:57] offset:0
    global_store_dwordx4 v1, v[32:35], s[56:57] offset:1024
    global_store_dwordx4 v1, v[32:35], s[56:57] offset:2048
    global_store_dwordx4 v1, v[32:35], s[56:57] offset:3072
    s_mov_b32 s52, 0
KB_m7h:
    global_load_dword v31, v30, s[66:67] offset:256 sc1
    s_add_u32 s52, s52, 1
    s_waitcnt vmcnt(0)
    v_cmp_ne_u32 vcc, 0x01010101, v31
    s_cbranch_vccz KB_m7h_d
    s_cmp_lt_u32 s52, 131072
    s_cbranch_scc1 KB_m7h
KB_m7h_d:
    s_add_u32 s53, s61, 7340032
    s_add_u32 s56, s8, s53
    s_addc_u32 s57, s9, 0
    global_load_dwordx4 v[200:203], v15, s[54:55] sc1
    global_load_dwordx4 v[204:207], v15, s[50:51] sc1
    global_store_dwordx4 v1, v[32:35], s[56:57] offset:0
    global_store_dwordx4 v1, v[32:35], s[56:57] offset:1024
    global_store_dwordx4 v1, v[32:35], s[56:57] offset:2048
    global_store_dwordx4 v1, v[32:35], s[56:57] offset:3072
    s_add_u32 s56, s56, 4096
    s_addc_u32 s57, s57, 0
    global_store_dwordx4 v1, v[32:35], s[56:57] offset:0
    global_store_dwordx4 v1, v[32:35], s[56:57] offset:1024
    global_store_dwordx4 v1, v[32:35], s[56:57] offset:2048
    global_store_dwordx4 v1, v[32:35], s[56:57] offset:3072
    s_add_u32 s56, s56, 4096
    s_addc_u32 s57, s57, 0
    global_store_dwordx4 v1, v[32:35], s[56:57] offset:0
    global_store_dwordx4 v1, v[32:35], s[56:57] offset:1024
    global_store_dwordx4 v1, v[32:35], s[56:57] offset:2048
    global_store_dwordx4 v1, v[32:35], s[56:57] offset:3072
    s_add_u32 s56, s56, 4096
    s_addc_u32 s57, s57, 0
    global_store_dwordx4 v1, v[32:35], s[56:57] offset:0
    global_store_dwordx4 v1, v[32:35], s[56:57] offset:1024
    global_store_dwordx4 v1, v[32:35], s[56:57] offset:2048
    global_store_dwordx4 v1, v[32:35], s[56:57] offset:3072
    s_waitcnt vmcnt(16)
    v_lshlrev_b32 v96, 16, v200
    v_and_b32 v97, 0xffff0000, v200
    v_lshlrev_b32 v98, 16, v201
    v_and_b32 v99, 0xffff0000, v201
    v_lshlrev_b32 v100, 16, v202
    v_and_b32 v101, 0xffff0000, v202
    v_lshlrev_b32 v102, 16, v203
    v_and_b32 v103, 0xffff0000, v203
    v_lshlrev_b32 v104, 16, v204
    v_and_b32 v105, 0xffff0000, v204
    v_lshlrev_b32 v106, 16, v205
    v_and_b32 v107, 0xffff0000, v205
    v_lshlrev_b32 v108, 16, v206
    v_and_b32 v109, 0xffff0000, v206
    v_lshlrev_b32 v110, 16, v207
    v_and_b32 v111, 0xffff0000, v207
    v_and_b32 v24, 1, v5
    v_lshlrev_b32 v24, 4, v24
    v_lshlrev_b32 v24, v24, s62
    v_lshrrev_b32 v25, 3, v5
    v_bfe_u32 v27, v5, 1, 1
    v_lshl_add_u32 v25, v25, 1, v27
    v_bfe_u32 v27, v5, 2, 1
    v_xor_b32 v27, v27, v2
    v_lshl_add_u32 v25, v27, 3, v25
    v_cmp_eq_u32 s[48:49], 0, v25
    v_cmp_eq_u32 s[56:57], 1, v25
    v_cmp_eq_u32 s[62:63], 2, v25
    v_cmp_eq_u32 s[52:53], 3, v25
    v_cndmask_b32 v200, 0, v24, s[48:49]
    v_cndmask_b32 v201, 0, v24, s[56:57]
    v_cndmask_b32 v202, 0, v24, s[62:63]
    v_cndmask_b32 v203, 0, v24, s[52:53]
    s_barrier
    s_mov_b32 s52, 0
KB_m7d:
    global_load_dword v31, v30, s[66:67] offset:896 sc1
    s_add_u32 s52, s52, 1
    s_waitcnt vmcnt(0)
    v_cmp_ne_u32 vcc, 0x01010101, v31
    s_cbranch_vccz KB_m7d_d
    s_cmp_lt_u32 s52, 131072
    s_cbranch_scc1 KB_m7d
KB_m7d_d:
    s_mul_i32 s53, s3, 2*7168
    s_mul_i32 s52, s15, 8192
    s_add_u32 s53, s53, s52
    s_add_u32 s56, s54, s53
    s_addc_u32 s57, s55, 0
    global_store_dwordx4 v1, v[32:35], s[56:57] offset:0
    global_store_dwordx4 v1, v[32:35], s[56:57] offset:1024
    global_store_dwordx4 v1, v[32:35], s[56:57] offset:2048
    global_store_dwordx4 v1, v[32:35], s[56:57] offset:3072
    s_add_u32 s56, s56, 4096
    s_addc_u32 s57, s57, 0
    global_store_dwordx4 v1, v[32:35], s[56:57] offset:0
    global_store_dwordx4 v1, v[32:35], s[56:57] offset:1024
    global_store_dwordx4 v1, v[32:35], s[56:57] offset:2048
    global_store_dwordx4 v1, v[32:35], s[56:57] offset:3072
    s_add_u32 s56, s56, 4096
    s_addc_u32 s57, s57, 0
    global_store_dwordx4 v1, v[32:35], s[56:57] offset:0
    global_store_dwordx4 v1, v[32:35], s[56:57] offset:1024
    global_store_dwordx4 v1, v[32:35], s[56:57] offset:2048
    global_store_dwordx4 v1, v[32:35], s[56:57] offset:3072
    s_add_u32 s56, s56, 4096
    s_addc_u32 s57, s57, 0
    global_store_dwordx4 v1, v[32:35], s[56:57] offset:0
    global_store_dwordx4 v1, v[32:35], s[56:57] offset:1024
    s_waitcnt vmcnt(0)
    s_barrier
    v_mov_b32 v12, 0x01010101
    s_cmp_eq_u32 s3, 0
    s_cselect_b64 exec, 0x7f, 0
    global_store_dword v30, v12, s[66:67] offset:960
    s_mov_b64 exec, -1
    s_branch KB_p0spin_m
KB_m7z:
    s_mov_b32 s52, 0
KB_m7zh:
    global_load_dword v31, v30, s[66:67] offset:256 sc1
    s_add_u32 s52, s52, 1
    s_waitcnt vmcnt(0)
    v_cmp_ne_u32 vcc, 0x01010101, v31
    s_cbranch_vccz KB_m7zh_d
    s_cmp_lt_u32 s52, 131072
    s_cbranch_scc1 KB_m7zh
KB_m7zh_d:
    buffer_inv sc1
    s_waitcnt vmcnt(0)
    global_load_dwordx4 v[200:203], v15, s[54:55] sc1
    global_load_dwordx4 v[204:207], v15, s[50:51] sc1
    s_waitcnt vmcnt(0)
    v_lshlrev_b32 v96, 16, v200
    v_and_b32 v97, 0xffff0000, v200
    v_lshlrev_b32 v98, 16, v201
    v_and_b32 v99, 0xffff0000, v201
    v_lshlrev_b32 v100, 16, v202
    v_and_b32 v101, 0xffff0000, v202
    v_lshlrev_b32 v102, 16, v203
    v_and_b32 v103, 0xffff0000, v203
    v_lshlrev_b32 v104, 16, v204
    v_and_b32 v105, 0xffff0000, v204
    v_lshlrev_b32 v106, 16, v205
    v_and_b32 v107, 0xffff0000, v205
    v_lshlrev_b32 v108, 16, v206
    v_and_b32 v109, 0xffff0000, v206
    v_lshlrev_b32 v110, 16, v207
    v_and_b32 v111, 0xffff0000, v207
    v_and_b32 v24, 1, v5
    v_lshlrev_b32 v24, 4, v24
    v_lshlrev_b32 v24, v24, s62
    v_lshrrev_b32 v25, 3, v5
    v_bfe_u32 v27, v5, 1, 1
    v_lshl_add_u32 v25, v25, 1, v27
    v_bfe_u32 v27, v5, 2, 1
    v_xor_b32 v27, v27, v2
    v_lshl_add_u32 v25, v27, 3, v25
    v_cmp_eq_u32 s[48:49], 0, v25
    v_cmp_eq_u32 s[56:57], 1, v25
    v_cmp_eq_u32 s[62:63], 2, v25
    v_cmp_eq_u32 s[52:53], 3, v25
    v_cndmask_b32 v200, 0, v24, s[48:49]
    v_cndmask_b32 v201, 0, v24, s[56:57]
    v_cndmask_b32 v202, 0, v24, s[62:63]
    v_cndmask_b32 v203, 0, v24, s[52:53]
    s_barrier
    s_mov_b32 s52, 0
KB_m7zd:
    global_load_dword v31, v30, s[66:67] offset:896 sc1
    s_add_u32 s52, s52, 1
    s_waitcnt vmcnt(0)
    v_cmp_ne_u32 vcc, 0x01010101, v31
    s_cbranch_vccz KB_m7zd_d
    s_cmp_lt_u32 s52, 131072
    s_cbranch_scc1 KB_m7zd
KB_m7zd_d:
    v_mov_b32 v12, 0x01010101
    s_cmp_eq_u32 s3, 0
    s_cselect_b64 exec, 0x7f, 0
    global_store_dword v30, v12, s[66:67] offset:960 sc0 sc1
    s_mov_b64 exec, -1
    s_mov_b32 s52, 0
    s_branch KB_fz2
KB_hd_fence:
    s_mov_b64 exec, 1
    global_store_byte v10, v11, s[66:67] offset:896 sc0 sc1
    s_mov_b64 exec, -1
    s_branch KB_hd_done
KB_mkspin:
    s_mov_b32 s52, 0
KB_mkspin_l:
    global_load_ubyte v4, v10, s[66:67] offset:960 sc1
    s_add_u32 s52, s52, 1
    s_waitcnt vmcnt(0)
    v_cmp_ne_u32 vcc, 1, v4
    s_cbranch_vccz KB_mkspin_done
    s_cmp_lt_u32 s52, 131072
    s_cbranch_scc1 KB_mkspin_l
    s_branch KB_mkspin_done
KB_fz:
    s_waitcnt vmcnt(0)
    buffer_wbl2 sc1
    s_waitcnt vmcnt(0)
    s_mov_b64 exec, 1
    global_store_byte v10, v11, s[66:67] offset:384 sc0 sc1
    s_mov_b64 exec, -1
    s_mov_b32 s52, 0
KB_fz2:
    global_load_dword v31, v30, s[66:67] offset:384 sc0 sc1
    s_add_u32 s52, s52, 1
    s_waitcnt vmcnt(0)
    v_cmp_ne_u32 vcc, 0x01010101, v31
    s_cbranch_vccz KB_fz3
    s_cmp_lt_u32 s52, 131072
    s_cbranch_scc1 KB_fz2
KB_fz3:
    buffer_inv sc1
    s_waitcnt vmcnt(0) lgkmcnt(0)
    global_load_dword v18, v16, s[54:55] offset:0 sc1
    global_load_dword v19, v16, s[54:55] offset:128 sc1
    global_load_dwordx4 v[144:147], v17, s[32:33] offset:-3584 sc1
    global_load_dwordx4 v[148:151], v17, s[32:33] offset:0 sc1
    global_load_dwordx4 v[152:155], v17, s[32:33] offset:3584 sc1
    global_load_dwordx4 v[156:159], v17, s[34:35] offset:-3584 sc1
    global_load_dwordx4 v[160:163], v17, s[34:35] offset:0 sc1
    global_load_dwordx4 v[164:167], v17, s[34:35] offset:3584 sc1
    global_load_dwordx4 v[168:171], v17, s[36:37] offset:-3584 sc1
    global_load_dwordx4 v[172:175], v28, s[8:9] offset:-3072 sc1
    global_load_dwordx4 v[176:179], v28, s[8:9] offset:-2048 sc1
    global_load_dwordx4 v[180:183], v28, s[8:9] offset:-1024 sc1
    global_load_dwordx4 v[184:187], v28, s[8:9] offset:0 sc1
    global_load_dwordx4 v[188:191], v28, s[8:9] offset:1024 sc1
    global_load_dwordx4 v[192:195], v28, s[8:9] offset:2048 sc1
    global_load_dwordx4 v[196:199], v28, s[8:9] offset:3072 sc1
    s_waitcnt vmcnt(0)
    s_branch KB_go
KB_xcc:
    s_mov_b32 s68, 0
    s_branch KB_xcc_done
KB_ost_fence:
    v_pk_mul_f32 v[40:41], v[40:41], v[12:13] op_sel_hi:[1,0]
    v_pk_mul_f32 v[42:43], v[42:43], v[12:13] op_sel_hi:[1,0]
    v_pk_mul_f32 v[44:45], v[44:45], v[12:13] op_sel_hi:[1,0]
    v_pk_mul_f32 v[46:47], v[46:47], v[12:13] op_sel_hi:[1,0]
    s_nop 0
    v_cvt_pk_bf16_f32 v48, v32, v33
    v_cvt_pk_bf16_f32 v49, v34, v35
    v_cvt_pk_bf16_f32 v50, v36, v37
    v_cvt_pk_bf16_f32 v51, v38, v39
    v_cvt_pk_bf16_f32 v52, v40, v41
    v_cvt_pk_bf16_f32 v53, v42, v43
    v_cvt_pk_bf16_f32 v54, v44, v45
    v_cvt_pk_bf16_f32 v55, v46, v47
    global_store_dwordx4 v24, v[48:51], s[20:21] offset:0 sc0 sc1
    global_store_dwordx4 v24, v[52:55], s[20:21] offset:1024 sc0 sc1
    s_branch KB_ost_done
KB_sg0_fence:
    buffer_wbl2 sc1
    s_waitcnt vmcnt(0)
    s_mov_b64 exec, 1
    global_store_byte v10, v11, s[66:67] offset:128 sc0 sc1
    s_mov_b64 exec, -1
    s_branch KB_sg0_done
KB_pl0_fence:
    global_load_dwordx4 a[176:179], v1, s[98:99] offset:-4096
    global_load_dwordx4 a[180:183], v1, s[98:99] offset:-3072
    global_load_dwordx4 a[184:187], v1, s[98:99] offset:-2048
    global_load_dwordx4 a[188:191], v1, s[98:99] offset:-1024
    global_load_dwordx4 a[192:195], v1, s[98:99] offset:0
    global_load_dwordx4 a[196:199], v1, s[98:99] offset:1024
    global_load_dwordx4 a[200:203], v1, s[98:99] offset:2048
    global_load_dwordx4 a[204:207], v1, s[98:99] offset:3072
KB_pl0_floop:
    global_load_dword v31, v30, s[66:67] offset:128 sc0 sc1
    s_add_u32 s52, s52, 1
    s_waitcnt vmcnt(0)
    v_cmp_ne_u32 vcc, 0x01010101, v31
    s_cbranch_vccz KB_pl0_fdone
    s_cmp_lt_u32 s52, 131072
    s_cbranch_scc1 KB_pl0_floop
KB_pl0_fdone:
    buffer_inv sc1
    s_waitcnt vmcnt(0) lgkmcnt(0)
    s_branch KB_pl0_done
KB_sg1_fence:
    buffer_wbl2 sc1
    s_waitcnt vmcnt(0)
    s_mov_b64 exec, 1
    global_store_byte v10, v11, s[66:67] offset:256 sc0 sc1
    s_mov_b64 exec, -1
    s_branch KB_sg1_done
KB_pl1_fence:
    global_load_dwordx4 v[32:35], v8, s[96:97] sc1
    global_load_dwordx4 v[36:39], v8, s[98:99] sc1
    global_load_dwordx4 a[224:227], v1, s[32:33] offset:-4096
    global_load_dwordx4 a[228:231], v1, s[32:33] offset:-3072
    global_load_dwordx4 a[232:235], v1, s[32:33] offset:-2048
KB_pl1_floop:
    global_load_dword v31, v30, s[66:67] offset:256 sc0 sc1
    s_add_u32 s52, s52, 1
    s_waitcnt vmcnt(0)
    v_cmp_ne_u32 vcc, 0x01010101, v31
    s_cbranch_vccz KB_pl1_fdone
    s_cmp_lt_u32 s52, 131072
    s_cbranch_scc1 KB_pl1_floop
KB_pl1_fdone:
    buffer_inv sc1
    s_waitcnt vmcnt(0) lgkmcnt(0)
    s_branch KB_pl1_done
KB_wspin:
    s_mov_b32 s68, 0
KB_wspin_loop:
    global_load_dwordx4 v[16:19], v20, s[8:9] sc1
    s_add_u32 s68, s68, 1
    s_waitcnt vmcnt(0)
    v_and_b32 v16, v16, v17
    v_and_b32 v18, v18, v19
    v_and_b32 v16, v16, v18
    v_and_b32 v16, 0x10101010, v16
    v_cmp_ne_u32 vcc, 0x10101010, v16
    s_cbranch_vccz KB_wspin_done
    s_cmp_lt_u32 s68, 131072
    s_cbranch_scc1 KB_wspin_loop
    s_branch KB_wspin_done
KB_rspin:
    s_mov_b32 s52, 0
KB_rspin_loop:
    global_load_dword v4, v31, s[8:9] sc1
    s_add_u32 s52, s52, 1
    s_waitcnt vmcnt(0)
    v_cmp_ne_u32 vcc, 0x01010101, v4
    s_cbranch_vccz KB_rspin_done
    s_cmp_lt_u32 s52, 131072
    s_cbranch_scc1 KB_rspin_loop
    s_branch KB_rspin_done
P1_ack_q:
    s_mov_b32 s52, 0
P1_ack_q_loop:
    global_load_dword v137, v142, s[92:93] offset:0 sc1
    s_add_u32 s52, s52, 1
    s_waitcnt vmcnt(0)
    v_cmp_ne_u32 vcc, 0x01010101, v137
    s_cbranch_vccz P1_ack_q_done
    s_cmp_lt_u32 s52, 131072
    s_cbranch_scc1 P1_ack_q_loop
    s_branch P1_ack_q_done
P1_again:
    s_mov_b32 s7, 0
P1_again_l:
    global_load_dword v207, v28, s[8:9] offset:512 sc1
    global_load_dwordx4 v[64:67], v1, s[32:33] offset:-4096 sc1
    global_load_dwordx4 v[68:71], v1, s[32:33] offset:-3072 sc1
    global_load_dwordx4 v[72:75], v1, s[32:33] offset:-2048 sc1
    global_load_dwordx4 v[76:79], v1, s[32:33] offset:-1024 sc1
    global_load_dwordx4 v[80:83], v1, s[32:33] offset:0 sc1
    global_load_dwordx4 v[84:87], v1, s[32:33] offset:1024 sc1
    global_load_dwordx4 v[88:91], v1, s[32:33] offset:2048 sc1
    global_load_dwordx4 v[92:95], v1, s[32:33] offset:3072 sc1
    s_add_u32 s7, s7, 1
    s_waitcnt vmcnt(0)
    v_cmp_ne_u32 s[52:53], s69, v207
    v_max3_u32 v205, v64, v68, v72
    v_max3_u32 v206, v80, v84, v88
    s_and_b64 s[52:53], s[52:53], 0xff00
    v_max3_u32 v205, v205, v76, v92
    v_max_u32 v205, v205, v206
    v_cmp_eq_u32 vcc, -1, v205
    s_nop 0
    s_or_b64 vcc, vcc, s[52:53]
    s_cbranch_vccz P1_kvok
    s_cmp_lt_u32 s7, 48
    s_cbranch_scc1 P1_again_l
    s_waitcnt lgkmcnt(0)
    v_and_b32 v154, v143, v154
    v_and_b32 v155, v143, v155
    v_and_b32 v158, v143, v158
    v_and_b32 v159, v143, v159
    v_mfma_f32_32x32x16_bf16 v[208:223], v[128:131], v[144:147], 0
    v_mfma_f32_32x32x16_bf16 v[224:239], v[128:131], v[148:151], 0
    v_mfma_f32_32x32x16_bf16 v[208:223], v[128:131], v[152:155], v[208:223]
    v_mfma_f32_32x32x16_bf16 v[224:239], v[128:131], v[156:159], v[224:239]
    global_load_dword v4, v31, s[8:9] sc1
    s_branch P1_far
P1_qagain:
    global_load_dword v29, v28, s[8:9] offset:512 sc1
    buffer_load_dwordx4 v[32:35], v18, s[16:19], s58 offen offset:0 sc1
    buffer_load_dwordx4 v[36:39], v18, s[16:19], s58 offen offset:1024 sc1
    buffer_load_dwordx4 v[40:43], v18, s[16:19], s59 offen offset:0 sc1
    buffer_load_dwordx4 v[44:47], v18, s[16:19], s59 offen offset:1024 sc1
    buffer_load_dwordx4 v[48:51], v18, s[16:19], s60 offen offset:0 sc1
    buffer_load_dwordx4 v[52:55], v18, s[16:19], s60 offen offset:1024 sc1
    buffer_load_dwordx4 v[56:59], v18, s[16:19], s61 offen offset:0 sc1
    buffer_load_dwordx4 v[60:63], v18, s[16:19], s61 offen offset:1024 sc1
    s_add_u32 s7, s7, 1
    s_cmp_lt_u32 s7, 48
    s_waitcnt vmcnt(0)
    s_cbranch_scc1 P1_qchk
P1_far:
    s_add_u32 s68, s68, 26214400
    s_cmp_eq_u32 s5, 0
    s_cbranch_scc1 P1_far_f
    buffer_store_dwordx2 v[112:113], v132, s[16:19], s68 offen sc0 sc1
    buffer_store_dwordx2 v[114:115], v133, s[16:19], s68 offen sc0 sc1
    buffer_store_dwordx2 v[116:117], v134, s[16:19], s68 offen sc0 sc1
    buffer_store_dwordx2 v[118:119], v135, s[16:19], s68 offen sc0 sc1
P1_far_f:
    v_mov_b32 v19, 1
    s_waitcnt vmcnt(0)
    s_mov_b64 exec, 1
    global_store_byte v16, v19, s[66:67] offset:640 sc0 sc1
    s_mov_b64 exec, -1
    s_sub_u32 s32, s32, 2752512
    s_subb_u32 s33, s33, 0
    s_mov_b32 s7, 0
P1_far_k:
    global_load_dword v4, v31, s[8:9] sc1
    global_load_dwordx4 v[64:67], v1, s[32:33] offset:-4096 sc1
    global_load_dwordx4 v[68:71], v1, s[32:33] offset:-3072 sc1
    global_load_dwordx4 v[72:75], v1, s[32:33] offset:-2048 sc1
    global_load_dwordx4 v[76:79], v1, s[32:33] offset:-1024 sc1
    global_load_dwordx4 v[80:83], v1, s[32:33] offset:0 sc1
    global_load_dwordx4 v[84:87], v1, s[32:33] offset:1024 sc1
    global_load_dwordx4 v[88:91], v1, s[32:33] offset:2048 sc1
    global_load_dwordx4 v[92:95], v1, s[32:33] offset:3072 sc1
    s_add_u32 s7, s7, 1
    s_waitcnt vmcnt(0)
    v_cmp_ne_u32 vcc, 0x01010101, v4
    v_max3_u32 v205, v64, v68, v72
    v_max3_u32 v206, v80, v84, v88
    s_mov_b64 s[52:53], vcc
    v_max3_u32 v205, v205, v76, v92
    v_max_u32 v205, v205, v206
    v_cmp_eq_u32 vcc, -1, v205
    s_nop 0
    s_or_b64 vcc, vcc, s[52:53]
    s_cbranch_vccz P1_far_kd
    s_cmp_lt_u32 s7, 131072
    s_cbranch_scc1 P1_far_k
P1_far_kd:
    s_mov_b32 s7, 0
P1_far_l:
    global_load_dword v207, v30, s[66:67] offset:640 sc0 sc1
    global_load_dword v29, v28, s[8:9] offset:512 sc1
    buffer_load_dwordx4 v[32:35], v18, s[16:19], s58 offen offset:0 sc1
    buffer_load_dwordx4 v[36:39], v18, s[16:19], s58 offen offset:1024 sc1
    buffer_load_dwordx4 v[40:43], v18, s[16:19], s59 offen offset:0 sc1
    buffer_load_dwordx4 v[44:47], v18, s[16:19], s59 offen offset:1024 sc1
    buffer_load_dwordx4 v[48:51], v18, s[16:19], s60 offen offset:0 sc1
    buffer_load_dwordx4 v[52:55], v18, s[16:19], s60 offen offset:1024 sc1
    buffer_load_dwordx4 v[56:59], v18, s[16:19], s61 offen offset:0 sc1
    buffer_load_dwordx4 v[60:63], v18, s[16:19], s61 offen offset:1024 sc1
    s_add_u32 s7, s7, 1
    s_waitcnt vmcnt(0)
    v_cmp_ne_u32 s[52:53], s69, v29
    v_cndmask_b32 v38, v38, 0, s[64:65]
    v_cndmask_b32 v39, v39, 0, s[64:65]
    v_cndmask_b32 v46, v46, 0, s[64:65]
    v_cndmask_b32 v47, v47, 0, s[64:65]
    v_cndmask_b32 v54, v54, 0, s[64:65]
    v_cndmask_b32 v55, v55, 0, s[64:65]
    v_cndmask_b32 v62, v62, 0, s[64:65]
    v_cndmask_b32 v63, v63, 0, s[64:65]
    v_max3_u32 v19, v32, v34, v36
    v_max3_u32 v29, v40, v42, v44
    v_mfma_f32_32x32x16_bf16 v[96:111], v[64:67], v[32:35], 0
    v_max3_u32 v19, v19, v48, v50
    v_max3_u32 v29, v29, v52, v56
    s_and_b64 s[52:53], s[52:53], 0xff
    v_max3_u32 v19, v19, v58, v60
    v_mfma_f32_32x32x16_bf16 v[96:111], v[68:71], v[36:39], v[96:111]
    v_max3_u32 v29, v29, v38, v46
    v_max3_u32 v19, v19, v54, v62
    v_max_u32 v19, v19, v29
    v_cmp_eq_u32 vcc, -1, v19
    s_mov_b64 s[0:1], -1
    s_or_b64 vcc, vcc, s[52:53]
    s_cbranch_vccz P1_ok
    v_cmp_ne_u32 vcc, 0x01010101, v207
    s_cbranch_vccz P1_far_d
    s_cmp_lt_u32 s7, 131072
    s_cbranch_scc1 P1_far_l
P1_far_d:
    v_add_u32 v18, 26214400, v18
    buffer_load_dwordx4 v[32:35], v18, s[16:19], s58 offen offset:0 sc1
    buffer_load_dwordx4 v[36:39], v18, s[16:19], s58 offen offset:1024 sc1
    buffer_load_dwordx4 v[40:43], v18, s[16:19], s59 offen offset:0 sc1
    buffer_load_dwordx4 v[44:47], v18, s[16:19], s59 offen offset:1024 sc1
    buffer_load_dwordx4 v[48:51], v18, s[16:19], s60 offen offset:0 sc1
    buffer_load_dwordx4 v[52:55], v18, s[16:19], s60 offen offset:1024 sc1
    buffer_load_dwordx4 v[56:59], v18, s[16:19], s61 offen offset:0 sc1
    buffer_load_dwordx4 v[60:63], v18, s[16:19], s61 offen offset:1024 sc1
    s_waitcnt vmcnt(0)
    v_cmp_ne_u32 s[52:53], s69, v29
    v_cndmask_b32 v38, v38, 0, s[64:65]
    v_cndmask_b32 v39, v39, 0, s[64:65]
    v_cndmask_b32 v46, v46, 0, s[64:65]
    v_cndmask_b32 v47, v47, 0, s[64:65]
    v_cndmask_b32 v54, v54, 0, s[64:65]
    v_cndmask_b32 v55, v55, 0, s[64:65]
    v_cndmask_b32 v62, v62, 0, s[64:65]
    v_cndmask_b32 v63, v63, 0, s[64:65]
    v_max3_u32 v19, v32, v34, v36
    v_max3_u32 v29, v40, v42, v44
    v_mfma_f32_32x32x16_bf16 v[96:111], v[64:67], v[32:35], 0
    v_max3_u32 v19, v19, v48, v50
    v_max3_u32 v29, v29, v52, v56
    s_and_b64 s[52:53], s[52:53], 0xff
    v_max3_u32 v19, v19, v58, v60
    v_mfma_f32_32x32x16_bf16 v[96:111], v[68:71], v[36:39], v[96:111]
    v_max3_u32 v29, v29, v38, v46
    v_max3_u32 v19, v19, v54, v62
    v_max_u32 v19, v19, v29
    v_cmp_eq_u32 vcc, -1, v19
    s_mov_b64 s[0:1], -1
    s_or_b64 vcc, vcc, s[52:53]
    s_branch P1_ok
KB_slow:
    s_mov_b64 s[0:1], 0
    buffer_inv sc1
    v_mov_b32 v136, 0xff800000
    v_mov_b32 v32, 0
    v_mov_b32 v33, 0
    v_mov_b32 v34, 0
    v_mov_b32 v35, 0
    v_mov_b32 v36, 0
    v_mov_b32 v37, 0
    v_mov_b32 v38, 0
    v_mov_b32 v39, 0
    v_mov_b32 v40, 0
    v_mov_b32 v41, 0
    v_mov_b32 v42, 0
    v_mov_b32 v43, 0
    v_mov_b32 v44, 0
    v_mov_b32 v45, 0
    v_mov_b32 v46, 0
    v_mov_b32 v47, 0
    s_mov_b32 s52, 2097152
KB_s1:
    buffer_load_dwordx4 v[64:67], v1, s[16:19], s52 offen offset:0 sc0 sc1
    buffer_load_dwordx4 v[68:71], v1, s[16:19], s52 offen offset:1024 sc0 sc1
    s_add_u32 s52, s52, 4096
    s_waitcnt vmcnt(0)
    v_mfma_f32_32x32x16_bf16 v[96:111], v[64:67], v[56:59], 0
    v_mfma_f32_32x32x16_bf16 v[96:111], v[68:71], v[60:63], v[96:111]
    s_nop 7
    s_nop 3
    v_max3_f32 v136, v96, v97, v136
    v_max3_f32 v136, v98, v99, v136
    v_max3_f32 v136, v100, v101, v136
    v_max3_f32 v136, v102, v103, v136
    v_max3_f32 v136, v104, v105, v136
    v_max3_f32 v136, v106, v107, v136
    v_max3_f32 v136, v108, v109, v136
    v_max3_f32 v136, v110, v111, v136
    s_cmp_lt_u32 s52, 2359296
    s_cbranch_scc1 KB_s1
    v_mov_b32 v12, v136
    s_nop 1
    v_permlane32_swap_b32 v12, v136
    s_nop 1
    v_max_f32 v136, v136, v12
    s_mov_b32 s52, 2097152
KB_s2:
    buffer_load_dwordx4 v[64:67], v1, s[16:19], s52 offen offset:0 sc0 sc1
    buffer_load_dwordx4 v[68:71], v1, s[16:19], s52 offen offset:1024 sc0 sc1
    buffer_load_dwordx4 v[72:75], v1, s[16:19], s52 offen offset:2048 sc0 sc1
    buffer_load_dwordx4 v[76:79], v1, s[16:19], s52 offen offset:3072 sc0 sc1
    s_add_u32 s52, s52, 4096
    s_waitcnt vmcnt(0)
    v_mfma_f32_32x32x16_bf16 v[96:111], v[64:67], v[56:59], 0
    v_mfma_f32_32x32x16_bf16 v[96:111], v[68:71], v[60:63], v[96:111]
    s_nop 7
    s_nop 3
    v_sub_f32 v96, v96, v136
    v_sub_f32 v97, v97, v136
    v_sub_f32 v98, v98, v136
    v_sub_f32 v99, v99, v136
    v_sub_f32 v100, v100, v136
    v_sub_f32 v101, v101, v136
    v_sub_f32 v102, v102, v136
    v_sub_f32 v103, v103, v136
    v_sub_f32 v104, v104, v136
    v_sub_f32 v105, v105, v136
    v_sub_f32 v106, v106, v136
    v_sub_f32 v107, v107, v136
    v_sub_f32 v108, v108, v136
    v_sub_f32 v109, v109, v136
    v_sub_f32 v110, v110, v136
    v_sub_f32 v111, v111, v136
    v_exp_f32 v96, v96
    v_exp_f32 v97, v97
    v_exp_f32 v98, v98
    v_exp_f32 v99, v99
    v_exp_f32 v100, v100
    v_exp_f32 v101, v101
    v_exp_f32 v102, v102
    v_exp_f32 v103, v103
    v_exp_f32 v104, v104
    v_exp_f32 v105, v105
    v_exp_f32 v106, v106
    v_exp_f32 v107, v107
    v_exp_f32 v108, v108
    v_exp_f32 v109, v109
    v_exp_f32 v110, v110
    v_exp_f32 v111, v111
    s_nop 0
    v_cvt_pk_bf16_f32 v128, v96, v97
    v_cvt_pk_bf16_f32 v129, v98, v99
    v_cvt_pk_bf16_f32 v130, v100, v101
    v_cvt_pk_bf16_f32 v131, v102, v103
    v_cvt_pk_bf16_f32 v132, v104, v105
    v_cvt_pk_bf16_f32 v133, v106, v107
    v_cvt_pk_bf16_f32 v134, v108, v109
    v_cvt_pk_bf16_f32 v135, v110, v111
    s_nop 1
    v_mfma_f32_32x32x16_bf16 v[32:47], v[72:75], v[128:131], v[32:47]
    v_mfma_f32_32x32x16_bf16 v[32:47], v[76:79], v[132:135], v[32:47]
    s_cmp_lt_u32 s52, 2359296
    s_cbranch_scc1 KB_s2
    s_nop 7
    s_nop 3
    v_mov_b32 v12, v44
    v_mov_b32 v13, v44
    s_nop 1
    v_permlane32_swap_b32 v12, v13
    s_nop 1
    v_rcp_f32 v12, v13
    v_mov_b32 v14, 0
    s_branch KB_norm
P1_ack_k:
    s_mov_b32 s52, 0
P1_ack_k_loop:
    global_load_dword v137, v142, s[92:93] offset:0 sc1
    s_add_u32 s52, s52, 1
    s_waitcnt vmcnt(0)
    v_cmp_ne_u32 vcc, 0x01010101, v137
    s_cbranch_vccz P1_ack_k_done
    s_cmp_lt_u32 s52, 131072
    s_cbranch_scc1 P1_ack_k_loop
    s_branch P1_ack_k_done
P1_ack_v:
    s_mov_b32 s52, 0
P1_ack_v_loop:
    global_load_dword v137, v142, s[92:93] offset:0 sc1
    s_add_u32 s52, s52, 1
    s_waitcnt vmcnt(0)
    v_cmp_ne_u32 vcc, 0x01010101, v137
    s_cbranch_vccz P1_ack_v_done
    s_cmp_lt_u32 s52, 131072
    s_cbranch_scc1 P1_ack_v_loop
    s_branch P1_ack_v_done
.p2align 12
P1_k:
    s_waitcnt vmcnt(12)
    s_barrier
    ds_read_b64_tr_b16 v[32:33], v182 offset:0
    ds_read_b64_tr_b16 v[34:35], v182 offset:224
    ds_read_b128 v[36:39], v196 offset:0
    ds_read_b64_tr_b16 v[40:41], v182 offset:896
    ds_read_b64_tr_b16 v[42:43], v182 offset:1120
    ds_read_b128 v[44:47], v197 offset:0
    ds_read_b64_tr_b16 v[48:49], v182 offset:1792
    ds_read_b64_tr_b16 v[50:51], v182 offset:2016
    ds_read_b128 v[52:55], v198 offset:0
    ds_read_b64_tr_b16 v[56:57], v182 offset:2688
    ds_read_b64_tr_b16 v[58:59], v182 offset:2912
    ds_read_b128 v[60:63], v199 offset:0
    ds_read_b128 v[188:191], v200 offset:0
    ds_read_b128 v[192:195], v201 offset:0
    s_add_u32 m0, s45, 3072
    s_add_u32 s49, s44, 384
    buffer_load_dwordx4 v181, s[8:11], s49 offen lds
    s_add_u32 m0, s45, 10240
    s_add_u32 s49, s44, 7552
    buffer_load_dwordx4 v181, s[8:11], s49 offen lds
    s_add_u32 m0, s47, 12288
    s_add_u32 s50, s46, 12288
    buffer_load_dwordx4 v1, s[12:15], s50 offen lds
    s_add_u32 m0, s47, 14336
    s_add_u32 s50, s46, 14336
    buffer_load_dwordx4 v1, s[12:15], s50 offen lds
    v_xor_b32 v184, v0, v176
    v_and_b32 v184, 1, v184
    v_mov_b32 v128, 0x3f803f80
    v_cmp_eq_u32 vcc, 0, v184
    v_mov_b32 v129, v128
    v_mov_b32 v130, v128
    v_mov_b32 v131, v128
    v_cndmask_b32 v124, 0, v128, vcc
    v_cndmask_b32 v125, 0, v128, vcc
    v_cndmask_b32 v126, 0, v128, vcc
    v_cndmask_b32 v127, 0, v128, vcc
    s_waitcnt vmcnt(12)
    s_barrier
    s_waitcnt lgkmcnt(0)
    v_mfma_f32_16x16x32_bf16 v[116:119], v[188:191], v[128:131], 0
    ds_read_b64_tr_b16 v[64:65], v182 offset:3584
    ds_read_b64_tr_b16 v[66:67], v182 offset:3808
    v_mfma_f32_16x16x32_bf16 v[120:123], v[188:191], v[188:191], 0
    ds_read_b128 v[68:71], v196 offset:1024
    ds_read_b64_tr_b16 v[72:73], v182 offset:4480
    v_mfma_f32_16x16x32_bf16 v[116:119], v[192:195], v[128:131], v[116:119]
    ds_read_b64_tr_b16 v[74:75], v182 offset:4704
    ds_read_b128 v[76:79], v197 offset:1024
    v_mfma_f32_16x16x32_bf16 v[120:123], v[192:195], v[192:195], v[120:123]
    ds_read_b64_tr_b16 v[80:81], v182 offset:5376
    ds_read_b64_tr_b16 v[82:83], v182 offset:5600
    v_mfma_f32_32x32x16_bf16 v[96:111], v[32:35], v[36:39], 0
    ds_read_b128 v[84:87], v198 offset:1024
    ds_read_b64_tr_b16 v[88:89], v182 offset:6272
    v_mfma_f32_16x16x32_bf16 v[112:115], v[32:35], v[124:127], 0
    ds_read_b64_tr_b16 v[90:91], v182 offset:6496
    ds_read_b128 v[92:95], v199 offset:1024
    v_mfma_f32_32x32x16_bf16 v[96:111], v[40:43], v[44:47], v[96:111]
    ds_read_b128 v[188:191], v200 offset:1024
    s_add_u32 m0, s45, 4096
    s_add_u32 s49, s44, 512
    buffer_load_dwordx4 v181, s[8:11], s49 offen lds
    s_lshl_b32 s52, s4, 12
    s_add_u32 s52, s52, 2359296
    s_add_u32 s66, s94, s52
    s_addc_u32 s67, s95, 0
    v_mfma_f32_16x16x32_bf16 v[112:115], v[40:43], v[124:127], v[112:115]
    s_add_u32 m0, s45, 11264
    s_add_u32 s49, s44, 7680
    buffer_load_dwordx4 v181, s[8:11], s49 offen lds
    v_mfma_f32_32x32x16_bf16 v[96:111], v[48:51], v[52:55], v[96:111]
    ds_read_b128 v[192:195], v201 offset:1024
    v_and_b32 v142, 1, v0
    v_lshlrev_b32 v142, 7, v142
    s_getreg_b32 s69, hwreg(HW_REG_XCC_ID, 0, 4)
    s_or_b32 s69, s69, 16
    v_mfma_f32_16x16x32_bf16 v[112:115], v[48:51], v[124:127], v[112:115]
    s_add_u32 m0, s47, 16384
    s_add_u32 s50, s46, 16384
    buffer_load_dwordx4 v1, s[12:15], s50 offen lds
    v_mfma_f32_32x32x16_bf16 v[96:111], v[56:59], v[60:63], v[96:111]
    v_mov_b32 v139, 0
    v_mov_b32 v140, 0
    v_mov_b32 v164, 0
    v_mov_b32 v132, 0
    v_mov_b32 v133, 0
    v_mov_b32 v134, 0
    v_mov_b32 v135, 0
    v_mfma_f32_16x16x32_bf16 v[112:115], v[56:59], v[124:127], v[112:115]
    s_add_u32 m0, s47, 18432
    s_add_u32 s50, s46, 18432
    buffer_load_dwordx4 v1, s[12:15], s50 offen lds
    s_waitcnt vmcnt(12)
    s_barrier
    s_waitcnt lgkmcnt(0)
    v_mfma_f32_16x16x32_bf16 v[116:119], v[188:191], v[128:131], v[116:119]
    ds_read_b64_tr_b16 v[32:33], v182 offset:7168
    ds_read_b64_tr_b16 v[34:35], v182 offset:7392
    v_mfma_f32_16x16x32_bf16 v[120:123], v[188:191], v[188:191], v[120:123]
    ds_read_b128 v[36:39], v196 offset:2048
    ds_read_b64_tr_b16 v[40:41], v182 offset:8064
    v_mfma_f32_16x16x32_bf16 v[116:119], v[192:195], v[128:131], v[116:119]
    ds_read_b64_tr_b16 v[42:43], v182 offset:8288
    ds_read_b128 v[44:47], v197 offset:2048
    v_mfma_f32_16x16x32_bf16 v[120:123], v[192:195], v[192:195], v[120:123]
    ds_read_b64_tr_b16 v[48:49], v182 offset:8960
    ds_read_b64_tr_b16 v[50:51], v182 offset:9184
    v_mfma_f32_32x32x16_bf16 v[96:111], v[64:67], v[68:71], v[96:111]
    ds_read_b128 v[52:55], v198 offset:2048
    ds_read_b64_tr_b16 v[56:57], v182 offset:9856
    v_mfma_f32_16x16x32_bf16 v[112:115], v[64:67], v[124:127], v[112:115]
    ds_read_b64_tr_b16 v[58:59], v182 offset:10080
    v_mfma_f32_32x32x16_bf16 v[96:111], v[72:75], v[76:79], v[96:111]
    ds_read_b128 v[188:191], v200 offset:2048
    ds_read_b128 v[60:63], v199 offset:2048
    v_mfma_f32_16x16x32_bf16 v[112:115], v[72:75], v[124:127], v[112:115]
    s_add_u32 m0, s45, 5120
    s_add_u32 s49, s44, 640
    buffer_load_dwordx4 v181, s[8:11], s49 offen lds
    v_mfma_f32_32x32x16_bf16 v[96:111], v[80:83], v[84:87], v[96:111]
    ds_read_b128 v[192:195], v201 offset:2048
    s_lshl_b32 s52, s3, 7
    s_add_u32 s53, s52, 131072
    v_and_b32 v184, 15, v0
    v_lshl_add_u32 v170, v184, 3, s53
    v_lshrrev_b32 v185, 4, v0
    v_cmp_eq_u32 vcc, v185, v177
    v_lshlrev_b32 v173, 3, v0
    v_add_u32 v173, 133120, v173
    v_cndmask_b32 v170, v173, v170, vcc
    s_add_u32 s52, s52, 131584
    v_lshlrev_b32 v185, 4, v185
    v_lshl_add_u32 v185, v184, 6, v185
    v_add_u32 v185, s52, v185
    v_cmp_gt_u32 vcc, 2, v184
    v_lshl_add_u32 v172, v2, 4, s52
    v_add_u32 v171, 133632, v1
    v_cndmask_b32 v171, v171, v185, vcc
    v_mfma_f32_16x16x32_bf16 v[112:115], v[80:83], v[124:127], v[112:115]
    s_add_u32 m0, s45, 12288
    s_add_u32 s49, s44, 7808
    buffer_load_dwordx4 v181, s[8:11], s49 offen lds
    v_mfma_f32_32x32x16_bf16 v[96:111], v[88:91], v[92:95], v[96:111]
    s_add_u32 m0, s47, 20480
    s_add_u32 s50, s46, 20480
    buffer_load_dwordx4 v1, s[12:15], s50 offen lds
    v_mfma_f32_16x16x32_bf16 v[112:115], v[88:91], v[124:127], v[112:115]
    s_add_u32 m0, s47, 22528
    s_add_u32 s50, s46, 22528
    buffer_load_dwordx4 v1, s[12:15], s50 offen lds
    s_waitcnt vmcnt(8)
    s_barrier
    s_waitcnt lgkmcnt(0)
    v_mfma_f32_16x16x32_bf16 v[116:119], v[188:191], v[128:131], v[116:119]
    ds_read_b64_tr_b16 v[64:65], v182 offset:10752
    ds_read_b64_tr_b16 v[66:67], v182 offset:10976
    v_mfma_f32_16x16x32_bf16 v[120:123], v[188:191], v[188:191], v[120:123]
    ds_read_b128 v[68:71], v196 offset:3072
    ds_read_b64_tr_b16 v[72:73], v182 offset:11648
    v_mfma_f32_16x16x32_bf16 v[116:119], v[192:195], v[128:131], v[116:119]
    ds_read_b64_tr_b16 v[74:75], v182 offset:11872
    ds_read_b128 v[76:79], v197 offset:3072
    v_mfma_f32_16x16x32_bf16 v[120:123], v[192:195], v[192:195], v[120:123]
    ds_read_b64_tr_b16 v[80:81], v182 offset:12544
    ds_read_b64_tr_b16 v[82:83], v182 offset:12768
    v_mfma_f32_32x32x16_bf16 v[96:111], v[32:35], v[36:39], v[96:111]
    ds_read_b128 v[84:87], v198 offset:3072
    ds_read_b64_tr_b16 v[88:89], v182 offset:13440
    v_mfma_f32_16x16x32_bf16 v[112:115], v[32:35], v[124:127], v[112:115]
    ds_read_b64_tr_b16 v[90:91], v182 offset:13664
    ds_read_b128 v[92:95], v199 offset:3072
    v_mfma_f32_32x32x16_bf16 v[96:111], v[40:43], v[44:47], v[96:111]
    ds_read_b128 v[188:191], v200 offset:3072
    s_add_u32 m0, s45, 6144
    s_add_u32 s49, s44, 768
    buffer_load_dwordx4 v181, s[8:11], s49 offen lds
    s_lshl_b32 s52, s7, 8
    s_add_u32 s52, s52, 131072
    v_lshl_add_u32 v173, v5, 3, s52
    v_and_b32 v184, 1, v0
    v_cmp_ne_u32 s[0:1], 0, v184
    v_mfma_f32_16x16x32_bf16 v[112:115], v[40:43], v[124:127], v[112:115]
    s_add_u32 m0, s45, 13312
    s_add_u32 s49, s44, 7936
    buffer_load_dwordx4 v181, s[8:11], s49 offen lds
    v_mfma_f32_32x32x16_bf16 v[96:111], v[48:51], v[52:55], v[96:111]
    ds_read_b128 v[192:195], v201 offset:3072
    s_lshl_b32 s52, s3, 8
    s_add_u32 s52, s52, 132096
    v_lshlrev_b32 v175, 2, v0
    v_add_u32 v174, s52, v175
    v_add_u32 v175, 132096, v175
    v_mfma_f32_16x16x32_bf16 v[112:115], v[48:51], v[124:127], v[112:115]
    s_add_u32 m0, s47, 24576
    s_add_u32 s50, s46, 24576
    buffer_load_dwordx4 v1, s[12:15], s50 offen lds
    v_mfma_f32_32x32x16_bf16 v[96:111], v[56:59], v[60:63], v[96:111]
    s_lshl_b32 s53, s5, 2
    s_add_u32 s53, s53, s3
    v_mov_b32 v16, s53
    v_mov_b32 v17, s69
    s_mul_i32 s69, s69, 0x01010101
    v_lshlrev_b32 v30, 2, v179
    v_mfma_f32_16x16x32_bf16 v[112:115], v[56:59], v[124:127], v[112:115]
    s_add_u32 m0, s47, 26624
    s_add_u32 s50, s46, 26624
    buffer_load_dwordx4 v1, s[12:15], s50 offen lds
    s_waitcnt vmcnt(8)
    s_barrier
    s_waitcnt lgkmcnt(0)
    v_mfma_f32_16x16x32_bf16 v[116:119], v[188:191], v[128:131], v[116:119]
    ds_read_b64_tr_b16 v[32:33], v182 offset:14336
    ds_read_b64_tr_b16 v[34:35], v182 offset:14560
    v_mfma_f32_16x16x32_bf16 v[120:123], v[188:191], v[188:191], v[120:123]
    ds_read_b128 v[36:39], v196 offset:4096
    ds_read_b64_tr_b16 v[40:41], v182 offset:15232
    v_mfma_f32_16x16x32_bf16 v[116:119], v[192:195], v[128:131], v[116:119]
    ds_read_b64_tr_b16 v[42:43], v182 offset:15456
    ds_read_b128 v[44:47], v197 offset:4096
    v_mfma_f32_16x16x32_bf16 v[120:123], v[192:195], v[192:195], v[120:123]
    ds_read_b64_tr_b16 v[48:49], v182 offset:16128
    v_mfma_f32_32x32x16_bf16 v[96:111], v[64:67], v[68:71], v[96:111]
    ds_read_b64_tr_b16 v[50:51], v182 offset:16352
    v_mfma_f32_16x16x32_bf16 v[112:115], v[64:67], v[124:127], v[112:115]
    ds_read_b128 v[52:55], v198 offset:4096
    v_mfma_f32_32x32x16_bf16 v[96:111], v[72:75], v[76:79], v[96:111]
    ds_read_b128 v[188:191], v200 offset:4096
    ds_read_b64_tr_b16 v[56:57], v182 offset:17024
    v_mfma_f32_16x16x32_bf16 v[112:115], v[72:75], v[124:127], v[112:115]
    ds_read_b64_tr_b16 v[58:59], v182 offset:17248
    v_mfma_f32_32x32x16_bf16 v[96:111], v[80:83], v[84:87], v[96:111]
    ds_read_b128 v[192:195], v201 offset:4096
    ds_read_b128 v[60:63], v199 offset:4096
    v_mfma_f32_16x16x32_bf16 v[112:115], v[80:83], v[124:127], v[112:115]
    global_load_dword v137, v142, s[92:93] offset:0 sc1
    v_mfma_f32_32x32x16_bf16 v[96:111], v[88:91], v[92:95], v[96:111]
    s_mov_b32 s24, s94
    s_mov_b32 s25, s95
    s_mov_b32 s26, 0
    s_mov_b32 s27, 0x20000
    v_mfma_f32_16x16x32_bf16 v[112:115], v[88:91], v[124:127], v[112:115]
    s_and_b32 s52, s2, 7
    s_lshl_b32 s53, s52, 7
    s_lshl_b32 s52, s3, 12
    s_add_u32 s53, s53, s52
    s_add_u32 s53, s53, 2360320
    v_lshl_add_u32 v31, v179, 14, s53
    s_waitcnt vmcnt(5)
    s_barrier
    s_waitcnt lgkmcnt(0)
    v_mfma_f32_16x16x32_bf16 v[116:119], v[188:191], v[128:131], v[116:119]
    ds_read_b64_tr_b16 v[64:65], v182 offset:17920
    ds_read_b64_tr_b16 v[66:67], v182 offset:18144
    v_mfma_f32_16x16x32_bf16 v[120:123], v[188:191], v[188:191], v[120:123]
    ds_read_b128 v[68:71], v196 offset:5120
    ds_read_b64_tr_b16 v[72:73], v182 offset:18816
    v_mfma_f32_16x16x32_bf16 v[116:119], v[192:195], v[128:131], v[116:119]
    ds_read_b64_tr_b16 v[74:75], v182 offset:19040
    v_mfma_f32_16x16x32_bf16 v[120:123], v[192:195], v[192:195], v[120:123]
    ds_read_b128 v[76:79], v197 offset:5120
    v_mfma_f32_32x32x16_bf16 v[96:111], v[32:35], v[36:39], v[96:111]
    ds_read_b64_tr_b16 v[80:81], v182 offset:19712
    v_mfma_f32_16x16x32_bf16 v[112:115], v[32:35], v[124:127], v[112:115]
    ds_read_b64_tr_b16 v[82:83], v182 offset:19936
    v_mfma_f32_32x32x16_bf16 v[96:111], v[40:43], v[44:47], v[96:111]
    ds_read_b128 v[188:191], v200 offset:5120
    ds_read_b128 v[84:87], v198 offset:5120
    v_mfma_f32_16x16x32_bf16 v[112:115], v[40:43], v[124:127], v[112:115]
    ds_read_b64_tr_b16 v[88:89], v182 offset:20608
    v_mfma_f32_32x32x16_bf16 v[96:111], v[48:51], v[52:55], v[96:111]
    ds_read_b128 v[192:195], v201 offset:5120
    ds_read_b64_tr_b16 v[90:91], v182 offset:20832
    v_mfma_f32_16x16x32_bf16 v[112:115], v[48:51], v[124:127], v[112:115]
    ds_read_b128 v[92:95], v199 offset:5120
    v_mfma_f32_32x32x16_bf16 v[96:111], v[56:59], v[60:63], v[96:111]
    s_and_b32 s52, s4, 28
    s_add_u32 s52, s52, s3
    s_lshl_b32 s52, s52, 12
    s_add_u32 s52, s52, 2359296
    s_lshl_b32 s53, s4, 12
    s_add_u32 s53, s53, 2359296
    v_and_b32 v184, 8, v0
    v_cmp_eq_u32 vcc, 0, v184
    v_add_u32 v28, s53, v30
    v_mov_b32 v184, s52
    v_cndmask_b32 v28, v184, v28, vcc
    v_mfma_f32_16x16x32_bf16 v[112:115], v[56:59], v[124:127], v[112:115]
    s_mov_b32 s10, s8
    s_mov_b32 s11, s9
    s_mov_b32 s8, s94
    s_mov_b32 s9, s95
    s_mov_b32 s12, s42
    s_mov_b32 s13, s43
    s_waitcnt vmcnt(1)
    s_barrier
    s_waitcnt lgkmcnt(0)
    v_mfma_f32_16x16x32_bf16 v[116:119], v[188:191], v[128:131], v[116:119]
    ds_read_b64_tr_b16 v[32:33], v182 offset:21504
    ds_read_b64_tr_b16 v[34:35], v182 offset:21728
    v_mfma_f32_16x16x32_bf16 v[120:123], v[188:191], v[188:191], v[120:123]
    ds_read_b128 v[36:39], v196 offset:6144
    ds_read_b64_tr_b16 v[40:41], v182 offset:22400
    v_mfma_f32_16x16x32_bf16 v[116:119], v[192:195], v[128:131], v[116:119]
    ds_read_b64_tr_b16 v[42:43], v182 offset:22624
    v_mfma_f32_16x16x32_bf16 v[120:123], v[192:195], v[192:195], v[120:123]
    ds_read_b128 v[44:47], v197 offset:6144
    v_mfma_f32_32x32x16_bf16 v[96:111], v[64:67], v[68:71], v[96:111]
    ds_read_b64_tr_b16 v[48:49], v182 offset:23296
    v_mfma_f32_16x16x32_bf16 v[112:115], v[64:67], v[124:127], v[112:115]
    ds_read_b64_tr_b16 v[50:51], v182 offset:23520
    v_mfma_f32_32x32x16_bf16 v[96:111], v[72:75], v[76:79], v[96:111]
    ds_read_b128 v[188:191], v200 offset:6144
    ds_read_b128 v[52:55], v198 offset:6144
    v_mfma_f32_16x16x32_bf16 v[112:115], v[72:75], v[124:127], v[112:115]
    ds_read_b64_tr_b16 v[56:57], v182 offset:24192
    v_mfma_f32_32x32x16_bf16 v[96:111], v[80:83], v[84:87], v[96:111]
    ds_read_b128 v[192:195], v201 offset:6144
    ds_read_b64_tr_b16 v[58:59], v182 offset:24416
    v_mfma_f32_16x16x32_bf16 v[112:115], v[80:83], v[124:127], v[112:115]
    ds_read_b128 v[60:63], v199 offset:6144
    v_mfma_f32_32x32x16_bf16 v[96:111], v[88:91], v[92:95], v[96:111]
    s_mov_b32 s14, s6
    s_mov_b32 s15, s7
    s_min_u32 s28, s5, 6
    s_lshl_b32 s6, s4, 3
    s_add_u32 s6, s6, s5
    s_lshl_b32 s29, s4, 16
    v_mfma_f32_16x16x32_bf16 v[112:115], v[88:91], v[124:127], v[112:115]
    s_lshl_b32 s52, s6, 13
    v_add_u32 v18, s52, v1
    s_and_b32 s52, s4, 28
    s_add_u32 s52, s52, s3
    s_lshl_b32 s52, s52, 13
    s_add_u32 s52, s52, 4853760
    s_add_u32 s32, s8, s52
    s_addc_u32 s33, s9, 0
    s_waitcnt lgkmcnt(0)
    v_mfma_f32_16x16x32_bf16 v[116:119], v[188:191], v[128:131], v[116:119]
    v_cmp_ne_u32 s[64:65], 0, v2
    v_cmp_lt_u32 s[62:63], 1, v6
    v_mfma_f32_16x16x32_bf16 v[120:123], v[188:191], v[188:191], v[120:123]
    s_add_u32 s58, s3, 1
    s_and_b32 s58, s58, 3
    s_lshl_b32 s58, s58, 11
    s_add_u32 s59, s58, 2048
    s_and_b32 s59, s59, 0x1800
    s_add_u32 s60, s59, 2048
    s_and_b32 s60, s60, 0x1800
    s_add_u32 s61, s60, 2048
    s_and_b32 s61, s61, 0x1800
    v_mfma_f32_16x16x32_bf16 v[116:119], v[192:195], v[128:131], v[116:119]
    v_lshlrev_b32 v19, 7, v0
    v_mov_b32 v4, 0x01010101
    v_mfma_f32_16x16x32_bf16 v[120:123], v[192:195], v[192:195], v[120:123]
    v_mfma_f32_32x32x16_bf16 v[96:111], v[32:35], v[36:39], v[96:111]
    v_mfma_f32_16x16x32_bf16 v[112:115], v[32:35], v[124:127], v[112:115]
    v_mfma_f32_32x32x16_bf16 v[96:111], v[40:43], v[44:47], v[96:111]
    v_mfma_f32_16x16x32_bf16 v[112:115], v[40:43], v[124:127], v[112:115]
    v_mfma_f32_32x32x16_bf16 v[96:111], v[48:51], v[52:55], v[96:111]
    v_mfma_f32_16x16x32_bf16 v[112:115], v[48:51], v[124:127], v[112:115]
    v_mfma_f32_32x32x16_bf16 v[96:111], v[56:59], v[60:63], v[96:111]
    v_mfma_f32_16x16x32_bf16 v[112:115], v[56:59], v[124:127], v[112:115]
    s_waitcnt vmcnt(0)
    v_cmp_ne_u32 vcc, 0x01010101, v137
    v_cndmask_b32 v116, v116, v117, s[0:1]
    v_cndmask_b32 v118, v118, v119, s[0:1]
    v_cndmask_b32 v120, v120, v121, s[0:1]
    v_cndmask_b32 v122, v122, v123, s[0:1]
    s_cbranch_vccnz P1_ack_k
P1_ack_k_done:
    s_mov_b64 exec, 1
    global_store_byte v16, v17, s[66:67] offset:512
    s_mov_b64 exec, -1
    v_cndmask_b32 v116, v116, v118, s[62:63]
    v_cndmask_b32 v120, v120, v122, s[62:63]
    v_mul_f32 v202, 0x3b124925, v116
    v_mul_f32 v204, 0x3b124925, v120
    v_fma_f32 v204, -v202, v202, v204
    v_max_f32 v204, 0, v204
    v_add_f32 v204, 0x3727c5ac, v204
    v_rsq_f32 v204, v204
    ds_write_b128 v171, v[112:115]
    v_mul_f32 v205, -v202, v204
    ds_write_b64 v170, v[204:205]
    ds_read_b128 v[32:35], v172 offset:0
    ds_read_b128 v[36:39], v172 offset:32
    ds_read_b128 v[40:43], v172 offset:64
    ds_read_b128 v[44:47], v172 offset:96
    s_waitcnt lgkmcnt(0)
    s_barrier
    ds_read_b64 v[202:203], v173
    s_waitcnt lgkmcnt(0)
    v_mul_f32 v96, v96, v202
    v_fmac_f32 v96, v32, v203
    v_mul_f32 v97, v97, v202
    v_fmac_f32 v97, v33, v203
    v_mul_f32 v98, v98, v202
    v_fmac_f32 v98, v34, v203
    v_mul_f32 v99, v99, v202
    v_fmac_f32 v99, v35, v203
    v_cvt_pk_bf16_f32 v112, v96, v97
    v_cvt_pk_bf16_f32 v113, v98, v99
    v_mul_f32 v100, v100, v202
    v_fmac_f32 v100, v36, v203
    v_mul_f32 v101, v101, v202
    v_fmac_f32 v101, v37, v203
    v_mul_f32 v102, v102, v202
    v_fmac_f32 v102, v38, v203
    v_mul_f32 v103, v103, v202
    v_fmac_f32 v103, v39, v203
    v_cvt_pk_bf16_f32 v114, v100, v101
    v_cvt_pk_bf16_f32 v115, v102, v103
    v_mul_f32 v104, v104, v202
    v_fmac_f32 v104, v40, v203
    v_mul_f32 v105, v105, v202
    v_fmac_f32 v105, v41, v203
    v_mul_f32 v106, v106, v202
    v_fmac_f32 v106, v42, v203
    v_mul_f32 v107, v107, v202
    v_fmac_f32 v107, v43, v203
    v_cvt_pk_bf16_f32 v116, v104, v105
    v_cvt_pk_bf16_f32 v117, v106, v107
    v_mul_f32 v108, v108, v202
    v_fmac_f32 v108, v44, v203
    v_mul_f32 v109, v109, v202
    v_fmac_f32 v109, v45, v203
    v_mul_f32 v110, v110, v202
    v_fmac_f32 v110, v46, v203
    v_mul_f32 v111, v111, v202
    v_fmac_f32 v111, v47, v203
    v_cvt_pk_bf16_f32 v118, v108, v109
    v_cvt_pk_bf16_f32 v119, v110, v111
    v_cndmask_b32 v118, v118, 0, s[64:65]
    v_cndmask_b32 v119, v119, 0, s[64:65]
    buffer_store_dwordx4 v[112:115], v1, s[16:19], s88 offen offset:0
    buffer_store_dwordx4 v[116:119], v1, s[16:19], s88 offen offset:1024
    buffer_store_dwordx4 v[112:115], v1, s[16:19], s68 offen offset:0 sc1
    buffer_store_dwordx4 v[116:119], v1, s[16:19], s68 offen offset:1024 sc1
    s_barrier
    s_cmp_eq_u32 s3, 0
    s_cbranch_scc0 P1_join
    s_mov_b64 exec, 0xff
    global_store_dword v19, v4, s[66:67] offset:1024 sc0 sc1
    s_mov_b64 exec, -1
    s_branch P1_join
.p2align 12
P1_v:
    s_waitcnt vmcnt(12)
    s_barrier
    ds_read_b64_tr_b16 v[32:33], v182 offset:0
    ds_read_b64_tr_b16 v[34:35], v182 offset:224
    ds_read_b128 v[36:39], v196 offset:0
    ds_read_b64_tr_b16 v[40:41], v182 offset:896
    ds_read_b64_tr_b16 v[42:43], v182 offset:1120
    ds_read_b128 v[44:47], v197 offset:0
    ds_read_b64_tr_b16 v[48:49], v182 offset:1792
    ds_read_b64_tr_b16 v[50:51], v182 offset:2016
    ds_read_b128 v[52:55], v198 offset:0
    ds_read_b64_tr_b16 v[56:57], v182 offset:2688
    ds_read_b64_tr_b16 v[58:59], v182 offset:2912
    ds_read_b128 v[60:63], v199 offset:0
    ds_read_b128 v[188:191], v200 offset:0
    ds_read_b128 v[192:195], v201 offset:0
    s_add_u32 m0, s45, 3072
    s_add_u32 s49, s44, 384
    buffer_load_dwordx4 v181, s[8:11], s49 offen lds
    s_add_u32 m0, s45, 10240
    s_add_u32 s49, s44, 7552
    buffer_load_dwordx4 v181, s[8:11], s49 offen lds
    s_add_u32 m0, s47, 12288
    s_add_u32 s50, s46, 12288
    buffer_load_dwordx4 v1, s[12:15], s50 offen lds
    s_add_u32 m0, s47, 14336
    s_add_u32 s50, s46, 14336
    buffer_load_dwordx4 v1, s[12:15], s50 offen lds
    v_xor_b32 v184, v0, v176
    v_and_b32 v184, 1, v184
    v_mov_b32 v128, 0x3f803f80
    v_cmp_eq_u32 vcc, 0, v184
    v_mov_b32 v129, v128
    v_mov_b32 v130, v128
    v_mov_b32 v131, v128
    v_cndmask_b32 v124, 0, v128, vcc
    v_cndmask_b32 v125, 0, v128, vcc
    v_cndmask_b32 v126, 0, v128, vcc
    v_cndmask_b32 v127, 0, v128, vcc
    s_waitcnt vmcnt(12)
    s_barrier
    s_waitcnt lgkmcnt(0)
    v_mfma_f32_16x16x32_bf16 v[116:119], v[188:191], v[128:131], 0
    ds_read_b64_tr_b16 v[64:65], v182 offset:3584
    ds_read_b64_tr_b16 v[66:67], v182 offset:3808
    v_mfma_f32_16x16x32_bf16 v[120:123], v[188:191], v[188:191], 0
    ds_read_b128 v[68:71], v196 offset:1024
    ds_read_b64_tr_b16 v[72:73], v182 offset:4480
    v_mfma_f32_16x16x32_bf16 v[116:119], v[192:195], v[128:131], v[116:119]
    ds_read_b64_tr_b16 v[74:75], v182 offset:4704
    ds_read_b128 v[76:79], v197 offset:1024
    v_mfma_f32_16x16x32_bf16 v[120:123], v[192:195], v[192:195], v[120:123]
    ds_read_b64_tr_b16 v[80:81], v182 offset:5376
    ds_read_b64_tr_b16 v[82:83], v182 offset:5600
    v_mfma_f32_32x32x16_bf16 v[96:111], v[36:39], v[32:35], 0
    ds_read_b128 v[84:87], v198 offset:1024
    ds_read_b64_tr_b16 v[88:89], v182 offset:6272
    v_mfma_f32_16x16x32_bf16 v[112:115], v[124:127], v[32:35], 0
    ds_read_b64_tr_b16 v[90:91], v182 offset:6496
    ds_read_b128 v[92:95], v199 offset:1024
    v_mfma_f32_32x32x16_bf16 v[96:111], v[44:47], v[40:43], v[96:111]
    ds_read_b128 v[188:191], v200 offset:1024
    s_add_u32 m0, s45, 4096
    s_add_u32 s49, s44, 512
    buffer_load_dwordx4 v181, s[8:11], s49 offen lds
    s_lshl_b32 s52, s4, 12
    s_add_u32 s52, s52, 2359296
    s_add_u32 s66, s94, s52
    s_addc_u32 s67, s95, 0
    v_mfma_f32_16x16x32_bf16 v[112:115], v[124:127], v[40:43], v[112:115]
    s_add_u32 m0, s45, 11264
    s_add_u32 s49, s44, 7680
    buffer_load_dwordx4 v181, s[8:11], s49 offen lds
    v_mfma_f32_32x32x16_bf16 v[96:111], v[52:55], v[48:51], v[96:111]
    ds_read_b128 v[192:195], v201 offset:1024
    v_and_b32 v142, 1, v0
    v_lshlrev_b32 v142, 7, v142
    s_getreg_b32 s69, hwreg(HW_REG_XCC_ID, 0, 4)
    s_or_b32 s69, s69, 16
    v_mfma_f32_16x16x32_bf16 v[112:115], v[124:127], v[48:51], v[112:115]
    s_add_u32 m0, s47, 16384
    s_add_u32 s50, s46, 16384
    buffer_load_dwordx4 v1, s[12:15], s50 offen lds
    v_mfma_f32_32x32x16_bf16 v[96:111], v[60:63], v[56:59], v[96:111]
    v_mov_b32 v139, 0
    v_mov_b32 v140, 0
    v_mov_b32 v164, 0
    v_mov_b32 v132, 0
    v_mov_b32 v133, 0
    v_mov_b32 v134, 0
    v_mov_b32 v135, 0
    v_mfma_f32_16x16x32_bf16 v[112:115], v[124:127], v[56:59], v[112:115]
    s_add_u32 m0, s47, 18432
    s_add_u32 s50, s46, 18432
    buffer_load_dwordx4 v1, s[12:15], s50 offen lds
    s_waitcnt vmcnt(12)
    s_barrier
    s_waitcnt lgkmcnt(0)
    v_mfma_f32_16x16x32_bf16 v[116:119], v[188:191], v[128:131], v[116:119]
    ds_read_b64_tr_b16 v[32:33], v182 offset:7168
    ds_read_b64_tr_b16 v[34:35], v182 offset:7392
    v_mfma_f32_16x16x32_bf16 v[120:123], v[188:191], v[188:191], v[120:123]
    ds_read_b128 v[36:39], v196 offset:2048
    ds_read_b64_tr_b16 v[40:41], v182 offset:8064
    v_mfma_f32_16x16x32_bf16 v[116:119], v[192:195], v[128:131], v[116:119]
    ds_read_b64_tr_b16 v[42:43], v182 offset:8288
    ds_read_b128 v[44:47], v197 offset:2048
    v_mfma_f32_16x16x32_bf16 v[120:123], v[192:195], v[192:195], v[120:123]
    ds_read_b64_tr_b16 v[48:49], v182 offset:8960
    ds_read_b64_tr_b16 v[50:51], v182 offset:9184
    v_mfma_f32_32x32x16_bf16 v[96:111], v[68:71], v[64:67], v[96:111]
    ds_read_b128 v[52:55], v198 offset:2048
    ds_read_b64_tr_b16 v[56:57], v182 offset:9856
    v_mfma_f32_16x16x32_bf16 v[112:115], v[124:127], v[64:67], v[112:115]
    ds_read_b64_tr_b16 v[58:59], v182 offset:10080
    ds_read_b128 v[60:63], v199 offset:2048
    v_mfma_f32_32x32x16_bf16 v[96:111], v[76:79], v[72:75], v[96:111]
    ds_read_b128 v[188:191], v200 offset:2048
    s_add_u32 m0, s45, 5120
    s_add_u32 s49, s44, 640
    buffer_load_dwordx4 v181, s[8:11], s49 offen lds
    v_mfma_f32_16x16x32_bf16 v[112:115], v[124:127], v[72:75], v[112:115]
    s_lshl_b32 s52, s3, 7
    s_add_u32 s53, s52, 131072
    v_and_b32 v184, 15, v0
    v_lshl_add_u32 v170, v184, 3, s53
    v_lshrrev_b32 v185, 4, v0
    v_cmp_eq_u32 vcc, v185, v177
    v_lshlrev_b32 v173, 3, v0
    v_add_u32 v173, 133120, v173
    v_cndmask_b32 v170, v173, v170, vcc
    v_mfma_f32_32x32x16_bf16 v[96:111], v[84:87], v[80:83], v[96:111]
    ds_read_b128 v[192:195], v201 offset:2048
    s_add_u32 m0, s45, 12288
    s_add_u32 s49, s44, 7808
    buffer_load_dwordx4 v181, s[8:11], s49 offen lds
    v_mfma_f32_16x16x32_bf16 v[112:115], v[124:127], v[80:83], v[112:115]
    s_lshl_b32 s52, s7, 8
    s_add_u32 s52, s52, 131072
    v_lshl_add_u32 v173, v2, 5, s52
    v_and_b32 v184, 1, v0
    v_cmp_ne_u32 s[0:1], 0, v184
    v_mfma_f32_32x32x16_bf16 v[96:111], v[92:95], v[88:91], v[96:111]
    s_add_u32 m0, s47, 20480
    s_add_u32 s50, s46, 20480
    buffer_load_dwordx4 v1, s[12:15], s50 offen lds
    v_mfma_f32_16x16x32_bf16 v[112:115], v[124:127], v[88:91], v[112:115]
    s_add_u32 m0, s47, 22528
    s_add_u32 s50, s46, 22528
    buffer_load_dwordx4 v1, s[12:15], s50 offen lds
    s_waitcnt vmcnt(8)
    s_barrier
    s_waitcnt lgkmcnt(0)
    v_mfma_f32_16x16x32_bf16 v[116:119], v[188:191], v[128:131], v[116:119]
    ds_read_b64_tr_b16 v[64:65], v182 offset:10752
    ds_read_b64_tr_b16 v[66:67], v182 offset:10976
    v_mfma_f32_16x16x32_bf16 v[120:123], v[188:191], v[188:191], v[120:123]
    ds_read_b128 v[68:71], v196 offset:3072
    ds_read_b64_tr_b16 v[72:73], v182 offset:11648
    v_mfma_f32_16x16x32_bf16 v[116:119], v[192:195], v[128:131], v[116:119]
    ds_read_b64_tr_b16 v[74:75], v182 offset:11872
    ds_read_b128 v[76:79], v197 offset:3072
    v_mfma_f32_16x16x32_bf16 v[120:123], v[192:195], v[192:195], v[120:123]
    ds_read_b64_tr_b16 v[80:81], v182 offset:12544
    ds_read_b64_tr_b16 v[82:83], v182 offset:12768
    v_mfma_f32_32x32x16_bf16 v[96:111], v[36:39], v[32:35], v[96:111]
    ds_read_b128 v[84:87], v198 offset:3072
    ds_read_b64_tr_b16 v[88:89], v182 offset:13440
    v_mfma_f32_16x16x32_bf16 v[112:115], v[124:127], v[32:35], v[112:115]
    ds_read_b64_tr_b16 v[90:91], v182 offset:13664
    ds_read_b128 v[92:95], v199 offset:3072
    v_mfma_f32_32x32x16_bf16 v[96:111], v[44:47], v[40:43], v[96:111]
    ds_read_b128 v[188:191], v200 offset:3072
    s_add_u32 m0, s45, 6144
    s_add_u32 s49, s44, 768
    buffer_load_dwordx4 v181, s[8:11], s49 offen lds
    s_lshl_b32 s52, s3, 8
    s_add_u32 s52, s52, 132096
    v_lshlrev_b32 v175, 2, v0
    v_add_u32 v174, s52, v175
    v_add_u32 v175, 132096, v175
    v_mfma_f32_16x16x32_bf16 v[112:115], v[124:127], v[40:43], v[112:115]
    s_add_u32 m0, s45, 13312
    s_add_u32 s49, s44, 7936
    buffer_load_dwordx4 v181, s[8:11], s49 offen lds
    v_mfma_f32_32x32x16_bf16 v[96:111], v[52:55], v[48:51], v[96:111]
    ds_read_b128 v[192:195], v201 offset:3072
    v_cmp_ne_u32 s[70:71], 0, v176
    v_cmp_eq_u32 vcc, 28, v5
    v_mov_b32 v187, 0x3f803f80
    v_cmp_lt_u32 s[90:91], 27, v5
    v_cndmask_b32 v187, 0, v187, vcc
    v_mfma_f32_16x16x32_bf16 v[112:115], v[124:127], v[48:51], v[112:115]
    s_add_u32 m0, s47, 24576
    s_add_u32 s50, s46, 24576
    buffer_load_dwordx4 v1, s[12:15], s50 offen lds
    v_mfma_f32_32x32x16_bf16 v[96:111], v[60:63], v[56:59], v[96:111]
    s_lshl_b32 s53, s5, 2
    s_add_u32 s53, s53, s3
    v_mov_b32 v16, s53
    v_mov_b32 v17, s69
    s_mul_i32 s69, s69, 0x01010101
    v_lshlrev_b32 v30, 2, v179
    v_mfma_f32_16x16x32_bf16 v[112:115], v[124:127], v[56:59], v[112:115]
    s_add_u32 m0, s47, 26624
    s_add_u32 s50, s46, 26624
    buffer_load_dwordx4 v1, s[12:15], s50 offen lds
    s_waitcnt vmcnt(8)
    s_barrier
    s_waitcnt lgkmcnt(0)
    v_mfma_f32_16x16x32_bf16 v[116:119], v[188:191], v[128:131], v[116:119]
    ds_read_b64_tr_b16 v[32:33], v182 offset:14336
    ds_read_b64_tr_b16 v[34:35], v182 offset:14560
    v_mfma_f32_16x16x32_bf16 v[120:123], v[188:191], v[188:191], v[120:123]
    ds_read_b128 v[36:39], v196 offset:4096
    ds_read_b64_tr_b16 v[40:41], v182 offset:15232
    v_mfma_f32_16x16x32_bf16 v[116:119], v[192:195], v[128:131], v[116:119]
    ds_read_b64_tr_b16 v[42:43], v182 offset:15456
    ds_read_b128 v[44:47], v197 offset:4096
    v_mfma_f32_16x16x32_bf16 v[120:123], v[192:195], v[192:195], v[120:123]
    ds_read_b64_tr_b16 v[48:49], v182 offset:16128
    v_mfma_f32_32x32x16_bf16 v[96:111], v[68:71], v[64:67], v[96:111]
    ds_read_b64_tr_b16 v[50:51], v182 offset:16352
    v_mfma_f32_16x16x32_bf16 v[112:115], v[124:127], v[64:67], v[112:115]
    ds_read_b128 v[52:55], v198 offset:4096
    v_mfma_f32_32x32x16_bf16 v[96:111], v[76:79], v[72:75], v[96:111]
    ds_read_b128 v[188:191], v200 offset:4096
    ds_read_b64_tr_b16 v[56:57], v182 offset:17024
    v_mfma_f32_16x16x32_bf16 v[112:115], v[124:127], v[72:75], v[112:115]
    ds_read_b64_tr_b16 v[58:59], v182 offset:17248
    v_mfma_f32_32x32x16_bf16 v[96:111], v[84:87], v[80:83], v[96:111]
    ds_read_b128 v[192:195], v201 offset:4096
    ds_read_b128 v[60:63], v199 offset:4096
    v_mfma_f32_16x16x32_bf16 v[112:115], v[124:127], v[80:83], v[112:115]
    global_load_dword v137, v142, s[92:93] offset:0 sc1
    v_mfma_f32_32x32x16_bf16 v[96:111], v[92:95], v[88:91], v[96:111]
    s_mov_b32 s24, s94
    s_mov_b32 s25, s95
    s_mov_b32 s26, 0
    s_mov_b32 s27, 0x20000
    v_mfma_f32_16x16x32_bf16 v[112:115], v[124:127], v[88:91], v[112:115]
    s_and_b32 s52, s2, 7
    s_lshl_b32 s53, s52, 7
    s_lshl_b32 s52, s3, 12
    s_add_u32 s53, s53, s52
    s_add_u32 s53, s53, 2360320
    v_lshl_add_u32 v31, v179, 14, s53
    s_waitcnt vmcnt(5)
    s_barrier
    s_waitcnt lgkmcnt(0)
    v_mfma_f32_16x16x32_bf16 v[116:119], v[188:191], v[128:131], v[116:119]
    ds_read_b64_tr_b16 v[64:65], v182 offset:17920
    ds_read_b64_tr_b16 v[66:67], v182 offset:18144
    v_mfma_f32_16x16x32_bf16 v[120:123], v[188:191], v[188:191], v[120:123]
    ds_read_b128 v[68:71], v196 offset:5120
    ds_read_b64_tr_b16 v[72:73], v182 offset:18816
    v_mfma_f32_16x16x32_bf16 v[116:119], v[192:195], v[128:131], v[116:119]
    ds_read_b64_tr_b16 v[74:75], v182 offset:19040
    v_mfma_f32_16x16x32_bf16 v[120:123], v[192:195], v[192:195], v[120:123]
    ds_read_b128 v[76:79], v197 offset:5120
    v_mfma_f32_32x32x16_bf16 v[96:111], v[36:39], v[32:35], v[96:111]
    ds_read_b64_tr_b16 v[80:81], v182 offset:19712
    v_mfma_f32_16x16x32_bf16 v[112:115], v[124:127], v[32:35], v[112:115]
    ds_read_b64_tr_b16 v[82:83], v182 offset:19936
    v_mfma_f32_32x32x16_bf16 v[96:111], v[44:47], v[40:43], v[96:111]
    ds_read_b128 v[188:191], v200 offset:5120
    ds_read_b128 v[84:87], v198 offset:5120
    v_mfma_f32_16x16x32_bf16 v[112:115], v[124:127], v[40:43], v[112:115]
    ds_read_b64_tr_b16 v[88:89], v182 offset:20608
    v_mfma_f32_32x32x16_bf16 v[96:111], v[52:55], v[48:51], v[96:111]
    ds_read_b128 v[192:195], v201 offset:5120
    ds_read_b64_tr_b16 v[90:91], v182 offset:20832
    v_mfma_f32_16x16x32_bf16 v[112:115], v[124:127], v[48:51], v[112:115]
    ds_read_b128 v[92:95], v199 offset:5120
    v_mfma_f32_32x32x16_bf16 v[96:111], v[60:63], v[56:59], v[96:111]
    s_and_b32 s52, s4, 28
    s_add_u32 s52, s52, s3
    s_lshl_b32 s52, s52, 12
    s_add_u32 s52, s52, 2359296
    s_lshl_b32 s53, s4, 12
    s_add_u32 s53, s53, 2359296
    v_and_b32 v184, 8, v0
    v_cmp_eq_u32 vcc, 0, v184
    v_add_u32 v28, s53, v30
    v_mov_b32 v184, s52
    v_cndmask_b32 v28, v184, v28, vcc
    v_mfma_f32_16x16x32_bf16 v[112:115], v[124:127], v[56:59], v[112:115]
    s_mov_b32 s10, s8
    s_mov_b32 s11, s9
    s_mov_b32 s8, s94
    s_mov_b32 s9, s95
    s_mov_b32 s12, s42
    s_mov_b32 s13, s43
    s_waitcnt vmcnt(1)
    s_barrier
    s_waitcnt lgkmcnt(0)
    v_mfma_f32_16x16x32_bf16 v[116:119], v[188:191], v[128:131], v[116:119]
    ds_read_b64_tr_b16 v[32:33], v182 offset:21504
    ds_read_b64_tr_b16 v[34:35], v182 offset:21728
    v_mfma_f32_16x16x32_bf16 v[120:123], v[188:191], v[188:191], v[120:123]
    ds_read_b128 v[36:39], v196 offset:6144
    ds_read_b64_tr_b16 v[40:41], v182 offset:22400
    v_mfma_f32_16x16x32_bf16 v[116:119], v[192:195], v[128:131], v[116:119]
    ds_read_b64_tr_b16 v[42:43], v182 offset:22624
    v_mfma_f32_16x16x32_bf16 v[120:123], v[192:195], v[192:195], v[120:123]
    ds_read_b128 v[44:47], v197 offset:6144
    v_mfma_f32_32x32x16_bf16 v[96:111], v[68:71], v[64:67], v[96:111]
    ds_read_b64_tr_b16 v[48:49], v182 offset:23296
    v_mfma_f32_16x16x32_bf16 v[112:115], v[124:127], v[64:67], v[112:115]
    ds_read_b64_tr_b16 v[50:51], v182 offset:23520
    v_mfma_f32_32x32x16_bf16 v[96:111], v[76:79], v[72:75], v[96:111]
    ds_read_b128 v[188:191], v200 offset:6144
    ds_read_b128 v[52:55], v198 offset:6144
    v_mfma_f32_16x16x32_bf16 v[112:115], v[124:127], v[72:75], v[112:115]
    ds_read_b64_tr_b16 v[56:57], v182 offset:24192
    v_mfma_f32_32x32x16_bf16 v[96:111], v[84:87], v[80:83], v[96:111]
    ds_read_b128 v[192:195], v201 offset:6144
    ds_read_b64_tr_b16 v[58:59], v182 offset:24416
    v_mfma_f32_16x16x32_bf16 v[112:115], v[124:127], v[80:83], v[112:115]
    ds_read_b128 v[60:63], v199 offset:6144
    v_mfma_f32_32x32x16_bf16 v[96:111], v[92:95], v[88:91], v[96:111]
    s_mov_b32 s14, s6
    s_mov_b32 s15, s7
    s_min_u32 s28, s5, 6
    s_lshl_b32 s6, s4, 3
    s_add_u32 s6, s6, s5
    s_lshl_b32 s29, s4, 16
    v_mfma_f32_16x16x32_bf16 v[112:115], v[124:127], v[88:91], v[112:115]
    s_lshl_b32 s52, s6, 13
    v_add_u32 v18, s52, v1
    s_and_b32 s52, s4, 28
    s_add_u32 s52, s52, s3
    s_lshl_b32 s52, s52, 13
    s_add_u32 s52, s52, 4853760
    s_add_u32 s32, s8, s52
    s_addc_u32 s33, s9, 0
    s_waitcnt lgkmcnt(0)
    v_mfma_f32_16x16x32_bf16 v[116:119], v[188:191], v[128:131], v[116:119]
    v_cmp_ne_u32 s[64:65], 0, v2
    v_cmp_lt_u32 s[62:63], 1, v6
    v_mfma_f32_16x16x32_bf16 v[120:123], v[188:191], v[188:191], v[120:123]
    s_add_u32 s58, s3, 1
    s_and_b32 s58, s58, 3
    s_lshl_b32 s58, s58, 11
    s_add_u32 s59, s58, 2048
    s_and_b32 s59, s59, 0x1800
    s_add_u32 s60, s59, 2048
    s_and_b32 s60, s60, 0x1800
    s_add_u32 s61, s60, 2048
    s_and_b32 s61, s61, 0x1800
    v_mfma_f32_16x16x32_bf16 v[116:119], v[192:195], v[128:131], v[116:119]
    v_lshlrev_b32 v19, 7, v0
    v_mov_b32 v4, 0x01010101
    v_mfma_f32_16x16x32_bf16 v[120:123], v[192:195], v[192:195], v[120:123]
    v_mfma_f32_32x32x16_bf16 v[96:111], v[36:39], v[32:35], v[96:111]
    v_mfma_f32_16x16x32_bf16 v[112:115], v[124:127], v[32:35], v[112:115]
    v_mfma_f32_32x32x16_bf16 v[96:111], v[44:47], v[40:43], v[96:111]
    v_mfma_f32_16x16x32_bf16 v[112:115], v[124:127], v[40:43], v[112:115]
    v_mfma_f32_32x32x16_bf16 v[96:111], v[52:55], v[48:51], v[96:111]
    v_mfma_f32_16x16x32_bf16 v[112:115], v[124:127], v[48:51], v[112:115]
    v_mfma_f32_32x32x16_bf16 v[96:111], v[60:63], v[56:59], v[96:111]
    v_mfma_f32_16x16x32_bf16 v[112:115], v[124:127], v[56:59], v[112:115]
    s_waitcnt vmcnt(0)
    v_cmp_ne_u32 vcc, 0x01010101, v137
    v_cndmask_b32 v116, v116, v117, s[0:1]
    v_cndmask_b32 v118, v118, v119, s[0:1]
    v_cndmask_b32 v120, v120, v121, s[0:1]
    v_cndmask_b32 v122, v122, v123, s[0:1]
    s_cbranch_vccnz P1_ack_v
P1_ack_v_done:
    s_mov_b64 exec, 1
    global_store_byte v16, v17, s[66:67] offset:512
    s_mov_b64 exec, -1
    v_cndmask_b32 v116, v116, v118, s[62:63]
    v_cndmask_b32 v120, v120, v122, s[62:63]
    v_mul_f32 v202, 0x3b124925, v116
    v_mul_f32 v204, 0x3b124925, v120
    v_fma_f32 v204, -v202, v202, v204
    v_max_f32 v204, 0, v204
    v_add_f32 v204, 0x3727c5ac, v204
    v_rsq_f32 v204, v204
    v_cndmask_b32 v112, v112, v113, s[70:71]
    v_mul_f32 v205, -v202, v204
    ds_write_b64 v170, v[204:205]
    s_waitcnt lgkmcnt(0)
    s_barrier
    ds_read_b128 v[32:35], v173 offset:0
    ds_read_b128 v[36:39], v173 offset:16
    ds_read_b128 v[40:43], v173 offset:64
    ds_read_b128 v[44:47], v173 offset:80
    ds_read_b128 v[48:51], v173 offset:128
    ds_read_b128 v[52:55], v173 offset:144
    ds_read_b128 v[56:59], v173 offset:192
    ds_read_b128 v[60:63], v173 offset:208
    s_waitcnt lgkmcnt(0)
    v_mul_f32 v96, v96, v32
    v_fmac_f32 v96, v33, v112
    v_mul_f32 v97, v97, v34
    v_fmac_f32 v97, v35, v112
    v_mul_f32 v98, v98, v36
    v_fmac_f32 v98, v37, v112
    v_mul_f32 v99, v99, v38
    v_fmac_f32 v99, v39, v112
    v_mul_f32 v100, v100, v40
    v_fmac_f32 v100, v41, v112
    v_mul_f32 v101, v101, v42
    v_fmac_f32 v101, v43, v112
    v_mul_f32 v102, v102, v44
    v_fmac_f32 v102, v45, v112
    v_mul_f32 v103, v103, v46
    v_fmac_f32 v103, v47, v112
    v_mul_f32 v104, v104, v48
    v_fmac_f32 v104, v49, v112
    v_mul_f32 v105, v105, v50
    v_fmac_f32 v105, v51, v112
    v_mul_f32 v106, v106, v52
    v_fmac_f32 v106, v53, v112
    v_mul_f32 v107, v107, v54
    v_fmac_f32 v107, v55, v112
    v_mul_f32 v108, v108, v56
    v_fmac_f32 v108, v57, v112
    v_mul_f32 v109, v109, v58
    v_fmac_f32 v109, v59, v112
    v_mul_f32 v110, v110, v60
    v_fmac_f32 v110, v61, v112
    v_mul_f32 v111, v111, v62
    v_fmac_f32 v111, v63, v112
    v_cvt_pk_bf16_f32 v112, v96, v97
    v_cvt_pk_bf16_f32 v113, v98, v99
    v_cvt_pk_bf16_f32 v114, v100, v101
    v_cvt_pk_bf16_f32 v115, v102, v103
    v_cvt_pk_bf16_f32 v116, v104, v105
    v_cvt_pk_bf16_f32 v117, v106, v107
    v_cvt_pk_bf16_f32 v118, v108, v109
    v_cvt_pk_bf16_f32 v119, v110, v111
    v_cndmask_b32 v112, v112, v187, s[90:91]
    v_cndmask_b32 v113, v113, v187, s[90:91]
    v_cndmask_b32 v114, v114, v187, s[90:91]
    v_cndmask_b32 v115, v115, v187, s[90:91]
    v_cndmask_b32 v116, v116, v187, s[90:91]
    v_cndmask_b32 v117, v117, v187, s[90:91]
    v_cndmask_b32 v118, v118, v187, s[90:91]
    v_cndmask_b32 v119, v119, v187, s[90:91]
    buffer_store_dwordx4 v[112:115], v1, s[16:19], s88 offen offset:0
    buffer_store_dwordx4 v[116:119], v1, s[16:19], s88 offen offset:1024
    buffer_store_dwordx4 v[112:115], v1, s[16:19], s68 offen offset:0 sc1
    buffer_store_dwordx4 v[116:119], v1, s[16:19], s68 offen offset:1024 sc1
    s_barrier
    s_branch P1_join
KB_code_end:
.section .rodata,"a"
.p2align 6
.amdhsa_kernel sequential_preLN__grouped_kv_mqa__dense_activation_mish__prompt_kernel
  .amdhsa_next_free_vgpr 512
  .amdhsa_next_free_sgpr 102
  .amdhsa_accum_offset 256
  .amdhsa_group_segment_fixed_size 0
  .amdhsa_kernarg_size 96
  .amdhsa_user_sgpr_count 2
  .amdhsa_user_sgpr_kernarg_segment_ptr 1
  .amdhsa_system_sgpr_workgroup_id_x 1
.end_amdhsa_kernel
```
